```python
import torch

def _softmax(x, axis=-1):
    return torch.softmax(x, dim=axis)
def _gelu(x):
    return torch.nn.functional.gelu(x, approximate="tanh")
def _silu(x):
    return torch.nn.functional.silu(x)
def _sigmoid(x):
    return torch.sigmoid(x)
def _layernorm(x, axis=-1, eps=1e-5):
    m = x.mean(dim=axis, keepdim=True)
    v = x.var(dim=axis, keepdim=True, unbiased=False)
    return (x - m) / torch.sqrt(v + eps)
def _scatter_add(tgt, idx, src, axis=0):
    return tgt.clone().index_add_(axis, idx, src)
def _segment_sum(src, seg, n):
    out = torch.zeros((n,) + src.shape[1:], dtype=src.dtype)
    return out.index_add_(0, seg, src)
def _pad(x, pw):
    flat = tuple(v for pair in reversed(pw) for v in pair)
    return torch.nn.functional.pad(x, flat)

kernel_name = 'standalone__gqa_softmax__near_ridge'

def setup_inputs():

    _w = (lambda a: (lambda t: t.to(torch.bfloat16) if t.is_floating_point() else t)(torch.as_tensor(a)))
    B, Hq, Hkv, Sq, Sk, D = 8, 32, 8, 48, 2048, 128
    return {
        "q": _w((lambda *s: torch.randn(*s, dtype=torch.bfloat16) * 0.8)(B, Hq, Sq, D)),
        "k": _w((lambda *s: torch.randn(*s, dtype=torch.bfloat16) * 0.8)(B, Hkv, Sk, D)),
        "v": _w((lambda *s: torch.randn(*s, dtype=torch.bfloat16) * 0.05)(B, Hkv, Sk, D)),
    }

def reference(q, k, v):
    B, Hq, Sq, D = q.shape
    Hkv = k.shape[1]
    rep = Hq // Hkv
    k = (lambda x, n, axis: torch.repeat_interleave(x, n, dim=axis))(k, rep, axis=1)
    v = (lambda x, n, axis: torch.repeat_interleave(x, n, dim=axis))(v, rep, axis=1)
    scale = D ** -0.5
    scores = torch.einsum("bhqd,bhkd->bhqk", q, k) * scale
    p = _softmax(scores, axis=-1)
    return torch.einsum("bhqk,bhkd->bhqd", p, v)
```

```asm
; @launch grid=(256,1,1) block=(512,1,1) lds=157952
.amdgcn_target "amdgcn-amd-amdhsa--gfx950"
.text
.globl standalone__gqa_softmax__near_ridge_kernel
.p2align 8
.type standalone__gqa_softmax__near_ridge_kernel,@function
standalone__gqa_softmax__near_ridge_kernel:
    s_load_dwordx8 s[4:11], s[0:1], 0
    s_load_dwordx4 s[12:15], s[0:1], 32
    s_cmp_ge_u32 s2, 256
    s_cbranch_scc1 L_end
    v_lshrrev_b32 v1, 6, v0
    s_and_b32 s16, s2, 7
    s_lshr_b32 s17, s2, 3
    v_readfirstlane_b32 s18, v1
    s_lshl_b32 s16, s16, 3
    s_lshr_b32 s19, s17, 2
    s_add_u32 s16, s16, s19
    s_and_b32 s17, s17, 3
    v_and_b32 v142, 63, v0
    v_lshlrev_b32 v143, 4, v142
    s_and_b32 s19, s18, 3
    s_mov_b32 s23, 0x20000
    s_mov_b32 s27, 0x20000
    s_mov_b32 s31, 0x20000
    s_cmp_ge_u32 s18, 4
    s_cbranch_scc1 L_loader
    s_lshl_b32 s36, s16, 2
    s_add_u32 s36, s36, s19
    s_mul_i32 s37, s36, 12288
    s_mov_b32 s22, 12288
    s_movk_i32 s38, 0x1000
    s_movk_i32 s39, 0x2000
    s_waitcnt lgkmcnt(0)
    s_add_u32 s20, s4, s37
    s_addc_u32 s21, s5, 0
    buffer_load_dwordx4 v[4:7], v143, s[20:23], 0 offen offset:0 nt
    buffer_load_dwordx4 v[16:19], v143, s[20:23], 0 offen offset:1024 nt
    buffer_load_dwordx4 v[28:31], v143, s[20:23], 0 offen offset:2048 nt
    buffer_load_dwordx4 v[40:43], v143, s[20:23], 0 offen offset:3072 nt
    buffer_load_dwordx4 v[8:11], v143, s[20:23], s38 offen offset:0 nt
    buffer_load_dwordx4 v[20:23], v143, s[20:23], s38 offen offset:1024 nt
    buffer_load_dwordx4 v[32:35], v143, s[20:23], s38 offen offset:2048 nt
    buffer_load_dwordx4 v[44:47], v143, s[20:23], s38 offen offset:3072 nt
    buffer_load_dwordx4 v[56:59], v143, s[20:23], s39 offen offset:0 nt
    buffer_load_dwordx4 v[68:71], v143, s[20:23], s39 offen offset:1024 nt
    buffer_load_dwordx4 v[80:83], v143, s[20:23], s39 offen offset:2048 nt
    buffer_load_dwordx4 v[92:95], v143, s[20:23], s39 offen offset:3072 nt
    s_barrier
    s_branch L_compute
L_loader:
    s_lshl_b32 s36, s19, 11
    s_lshl_b32 s37, s17, 6
    v_xor_b32 v2, s37, v143
    v_add_u32 v1, s36, v143
    v_add_u32 v2, s36, v2
    s_lshl_b32 s38, s16, 19
    s_lshl_b32 s39, s17, 17
    s_add_u32 s39, s38, s39
    s_mul_i32 s42, s19, 2112
    s_mov_b32 s22, 0x20000
    s_mov_b32 s26, 0x20000
    s_movk_i32 s30, 0x1000
    s_mul_i32 s44, s19, 1088
    s_add_u32 m0, s44, 153600
    v_and_b32 v5, 48, v142
    v_xor_b32 v5, v5, v143
    s_lshl_b32 s45, s19, 10
    s_mov_b32 s41, 0
    s_lshl_b32 s46, s16, 9
    s_lshl_b32 s47, s17, 2
    s_add_u32 s46, s46, s47
    s_add_u32 s46, s46, 25165824
    v_and_b32 v3, 3, v142
    v_lshlrev_b32 v3, 7, v3
    v_lshlrev_b32 v13, 2, v142
    s_mov_b32 s34, 0x10000000
    s_mov_b32 s35, 0x20000
    s_mov_b32 s50, 256
    s_mov_b32 s51, 0x20000
    s_cmp_ge_u32 s2, 32
    s_cbranch_scc1 L_nocpf
    s_getpc_b64 s[52:53]
L_pc:
    s_add_u32 s52, s52, L_nocpf-L_pc
    s_addc_u32 s53, s53, 0
    s_mov_b32 s54, L_general-L_nocpf
    s_mov_b32 s55, 0x20000
    s_lshr_b32 s56, s2, 3
    s_lshl_b32 s56, s56, 2
    s_add_u32 s56, s56, s19
    s_lshl_b32 s56, s56, 10
    buffer_load_dwordx4 v[20:23], v143, s[52:55], s56 offen
L_nocpf:
    s_waitcnt lgkmcnt(0)
    s_add_u32 s28, s6, s38
    s_addc_u32 s29, s7, 0
    buffer_load_dwordx4 v5, s[28:31], s45 offen lds
    s_add_u32 m0, s42, 118272
    s_add_u32 s20, s6, s39
    s_addc_u32 s21, s7, 0
    buffer_load_dwordx4 v1, s[20:23], s41 offen nt lds
    s_add_u32 m0, s42, 118304
    s_add_u32 s24, s8, s39
    s_addc_u32 s25, s9, 0
    buffer_load_dwordx4 v1, s[20:23], s41 offen offset:1024 nt lds
    s_mov_b32 s32, s14
    s_mov_b32 s33, s15
    s_mov_b32 s48, s12
    s_mov_b32 s49, s13
    s_cmp_lg_u32 s19, 0
    s_cbranch_scc1 L_nohs1
    buffer_load_dword v4, v3, s[32:35], s46 offen
L_nohs1:
    s_barrier
    s_add_u32 m0, s42, 0
    s_add_u32 s40, s41, 0x2000
    buffer_load_dwordx4 v1, s[20:23], s40 offen nt lds
    s_add_u32 m0, s42, 32
    s_nop 0
    buffer_load_dwordx4 v1, s[20:23], s40 offen offset:1024 nt lds
    s_add_u32 m0, s42, 8448
    s_nop 0
    buffer_load_dwordx4 v2, s[24:27], s41 offen nt lds
    s_add_u32 m0, s42, 8480
    s_nop 0
    buffer_load_dwordx4 v2, s[24:27], s41 offen offset:1024 nt lds
    s_mov_b32 s41, s40
    s_add_u32 m0, s42, 16896
    s_add_u32 s40, s41, 0x2000
    buffer_load_dwordx4 v1, s[20:23], s40 offen nt lds
    s_add_u32 m0, s42, 16928
    s_nop 0
    buffer_load_dwordx4 v1, s[20:23], s40 offen offset:1024 nt lds
    s_add_u32 m0, s42, 25344
    s_nop 0
    buffer_load_dwordx4 v2, s[24:27], s41 offen nt lds
    s_add_u32 m0, s42, 25376
    s_nop 0
    buffer_load_dwordx4 v2, s[24:27], s41 offen offset:1024 nt lds
    s_mov_b32 s41, s40
    s_waitcnt vmcnt(8)
    s_barrier
    s_add_u32 m0, s42, 33792
    s_add_u32 s40, s41, 0x2000
    buffer_load_dwordx4 v1, s[20:23], s40 offen nt lds
    s_add_u32 m0, s42, 33824
    s_nop 0
    buffer_load_dwordx4 v1, s[20:23], s40 offen offset:1024 nt lds
    s_add_u32 m0, s42, 42240
    s_nop 0
    buffer_load_dwordx4 v2, s[24:27], s41 offen nt lds
    s_add_u32 m0, s42, 42272
    s_nop 0
    buffer_load_dwordx4 v2, s[24:27], s41 offen offset:1024 nt lds
    s_mov_b32 s41, s40
    s_cmp_lg_u32 s19, 0
    s_cbranch_scc1 L_nohs2
    v_and_b32 v4, 1, v4
    v_cmp_eq_u32 vcc, 0, v4
    s_getreg_b32 s46, hwreg(HW_REG_XCC_ID)
    s_and_b32 s46, s46, 7
    s_lshl_b32 s46, s46, 4
    s_and_b32 s47, vcc_lo, 15
    s_or_b32 s46, s46, s47
    s_or_b32 s46, s46, 0x80
    s_lshl_b32 s47, s17, 3
    s_lshl_b32 s46, s46, s47
    v_mov_b32 v4, s46
    s_lshl_b32 s47, s16, 2
    s_mov_b64 exec, 1
    buffer_atomic_or v4, off, s[48:51], s47 sc1
    s_mov_b64 exec, -1
L_nohs2:
    s_waitcnt vmcnt(8)
    s_barrier
    s_add_u32 m0, s42, 50688
    s_add_u32 s40, s41, 0x2000
    buffer_load_dwordx4 v1, s[20:23], s40 offen nt lds
    s_add_u32 m0, s42, 50720
    s_nop 0
    buffer_load_dwordx4 v1, s[20:23], s40 offen offset:1024 nt lds
    s_add_u32 m0, s42, 59136
    s_nop 0
    buffer_load_dwordx4 v2, s[24:27], s41 offen nt lds
    s_add_u32 m0, s42, 59168
    s_nop 0
    buffer_load_dwordx4 v2, s[24:27], s41 offen offset:1024 nt lds
    s_mov_b32 s41, s40
    s_waitcnt vmcnt(8)
    s_barrier
    s_add_u32 m0, s42, 67584
    s_add_u32 s40, s41, 0x2000
    buffer_load_dwordx4 v1, s[20:23], s40 offen nt lds
    s_add_u32 m0, s42, 67616
    s_nop 0
    buffer_load_dwordx4 v1, s[20:23], s40 offen offset:1024 nt lds
    s_add_u32 m0, s42, 76032
    s_nop 0
    buffer_load_dwordx4 v2, s[24:27], s41 offen nt lds
    s_add_u32 m0, s42, 76064
    s_nop 0
    buffer_load_dwordx4 v2, s[24:27], s41 offen offset:1024 nt lds
    s_mov_b32 s41, s40
    s_waitcnt vmcnt(8)
    s_barrier
    s_add_u32 m0, s42, 84480
    s_add_u32 s40, s41, 0x2000
    buffer_load_dwordx4 v1, s[20:23], s40 offen nt lds
    s_add_u32 m0, s42, 84512
    s_nop 0
    buffer_load_dwordx4 v1, s[20:23], s40 offen offset:1024 nt lds
    s_add_u32 m0, s42, 92928
    s_nop 0
    buffer_load_dwordx4 v2, s[24:27], s41 offen nt lds
    s_add_u32 m0, s42, 92960
    s_nop 0
    buffer_load_dwordx4 v2, s[24:27], s41 offen offset:1024 nt lds
    s_mov_b32 s41, s40
    s_waitcnt vmcnt(8)
    s_barrier
    s_add_u32 m0, s42, 101376
    s_add_u32 s40, s41, 0x2000
    buffer_load_dwordx4 v1, s[20:23], s40 offen nt lds
    s_add_u32 m0, s42, 101408
    s_nop 0
    buffer_load_dwordx4 v1, s[20:23], s40 offen offset:1024 nt lds
    s_add_u32 m0, s42, 109824
    s_nop 0
    buffer_load_dwordx4 v2, s[24:27], s41 offen nt lds
    s_add_u32 m0, s42, 109856
    s_nop 0
    buffer_load_dwordx4 v2, s[24:27], s41 offen offset:1024 nt lds
    s_mov_b32 s41, s40
    s_waitcnt vmcnt(8)
    s_barrier
    s_add_u32 m0, s42, 118272
    s_add_u32 s40, s41, 0x2000
    buffer_load_dwordx4 v1, s[20:23], s40 offen nt lds
    s_add_u32 m0, s42, 118304
    s_nop 0
    buffer_load_dwordx4 v1, s[20:23], s40 offen offset:1024 nt lds
    s_add_u32 m0, s42, 126720
    s_nop 0
    buffer_load_dwordx4 v2, s[24:27], s41 offen nt lds
    s_add_u32 m0, s42, 126752
    s_nop 0
    buffer_load_dwordx4 v2, s[24:27], s41 offen offset:1024 nt lds
    s_mov_b32 s41, s40
    s_waitcnt vmcnt(8)
    s_barrier
    s_add_u32 m0, s42, 0
    s_add_u32 s40, s41, 0x2000
    buffer_load_dwordx4 v1, s[20:23], s40 offen nt lds
    s_add_u32 m0, s42, 32
    s_nop 0
    buffer_load_dwordx4 v1, s[20:23], s40 offen offset:1024 nt lds
    s_add_u32 m0, s42, 8448
    s_nop 0
    buffer_load_dwordx4 v2, s[24:27], s41 offen nt lds
    s_add_u32 m0, s42, 8480
    s_nop 0
    buffer_load_dwordx4 v2, s[24:27], s41 offen offset:1024 nt lds
    s_mov_b32 s41, s40
    s_waitcnt vmcnt(8)
    s_barrier
    s_add_u32 m0, s42, 16896
    s_add_u32 s40, s41, 0x2000
    buffer_load_dwordx4 v1, s[20:23], s40 offen nt lds
    s_add_u32 m0, s42, 16928
    s_nop 0
    buffer_load_dwordx4 v1, s[20:23], s40 offen offset:1024 nt lds
    s_add_u32 m0, s42, 25344
    s_nop 0
    buffer_load_dwordx4 v2, s[24:27], s41 offen nt lds
    s_add_u32 m0, s42, 25376
    s_nop 0
    buffer_load_dwordx4 v2, s[24:27], s41 offen offset:1024 nt lds
    s_mov_b32 s41, s40
    s_waitcnt vmcnt(8)
    s_barrier
    s_add_u32 m0, s42, 33792
    s_add_u32 s40, s41, 0x2000
    buffer_load_dwordx4 v1, s[20:23], s40 offen nt lds
    s_add_u32 m0, s42, 33824
    s_nop 0
    buffer_load_dwordx4 v1, s[20:23], s40 offen offset:1024 nt lds
    s_add_u32 m0, s42, 42240
    s_nop 0
    buffer_load_dwordx4 v2, s[24:27], s41 offen nt lds
    s_add_u32 m0, s42, 42272
    s_nop 0
    buffer_load_dwordx4 v2, s[24:27], s41 offen offset:1024 nt lds
    s_mov_b32 s41, s40
    s_waitcnt vmcnt(8)
    s_barrier
    s_add_u32 m0, s42, 50688
    s_add_u32 s40, s41, 0x2000
    buffer_load_dwordx4 v1, s[20:23], s40 offen nt lds
    s_add_u32 m0, s42, 50720
    s_nop 0
    buffer_load_dwordx4 v1, s[20:23], s40 offen offset:1024 nt lds
    s_add_u32 m0, s42, 59136
    s_nop 0
    buffer_load_dwordx4 v2, s[24:27], s41 offen nt lds
    s_add_u32 m0, s42, 59168
    s_nop 0
    buffer_load_dwordx4 v2, s[24:27], s41 offen offset:1024 nt lds
    s_mov_b32 s41, s40
    s_lshl_b32 s47, s16, 2
    buffer_load_dword v14, off, s[48:51], s47 sc1
    s_waitcnt vmcnt(9)
    s_barrier
    s_add_u32 m0, s42, 67584
    s_add_u32 s40, s41, 0x2000
    buffer_load_dwordx4 v1, s[20:23], s40 offen nt lds
    s_add_u32 m0, s42, 67616
    s_nop 0
    buffer_load_dwordx4 v1, s[20:23], s40 offen offset:1024 nt lds
    s_add_u32 m0, s42, 76032
    s_nop 0
    buffer_load_dwordx4 v2, s[24:27], s41 offen nt lds
    s_add_u32 m0, s42, 76064
    s_nop 0
    buffer_load_dwordx4 v2, s[24:27], s41 offen offset:1024 nt lds
    s_mov_b32 s41, s40
    s_waitcnt vmcnt(9)
    s_barrier
    s_add_u32 m0, s42, 84480
    s_add_u32 s40, s41, 0x2000
    buffer_load_dwordx4 v1, s[20:23], s40 offen nt lds
    s_add_u32 m0, s42, 84512
    s_nop 0
    buffer_load_dwordx4 v1, s[20:23], s40 offen offset:1024 nt lds
    s_add_u32 m0, s42, 92928
    s_nop 0
    buffer_load_dwordx4 v2, s[24:27], s41 offen nt lds
    s_add_u32 m0, s42, 92960
    s_nop 0
    buffer_load_dwordx4 v2, s[24:27], s41 offen offset:1024 nt lds
    s_mov_b32 s41, s40
    s_waitcnt vmcnt(8)
    s_barrier
    s_add_u32 m0, s42, 101376
    s_add_u32 s40, s41, 0x2000
    buffer_load_dwordx4 v1, s[20:23], s40 offen nt lds
    s_add_u32 m0, s42, 101408
    s_nop 0
    buffer_load_dwordx4 v1, s[20:23], s40 offen offset:1024 nt lds
    s_add_u32 m0, s42, 109824
    s_nop 0
    buffer_load_dwordx4 v2, s[24:27], s41 offen nt lds
    s_add_u32 m0, s42, 109856
    s_nop 0
    buffer_load_dwordx4 v2, s[24:27], s41 offen offset:1024 nt lds
    s_mov_b32 s41, s40
    s_waitcnt vmcnt(8)
    s_barrier
    s_add_u32 m0, s42, 126720
    s_nop 0
    buffer_load_dwordx4 v2, s[24:27], s41 offen nt lds
    s_add_u32 m0, s42, 126752
    s_nop 0
    buffer_load_dwordx4 v2, s[24:27], s41 offen offset:1024 nt lds
    s_mov_b32 s41, s40
    v_readfirstlane_b32 s36, v14
    s_lshr_b32 s37, s36, 8
    s_xor_b32 s37, s37, s36
    s_and_b32 s37, s37, 0x00f0f0f0
    s_andn2_b32 s36, 0x80, s36
    s_or_b32 s37, s37, s36
    s_cselect_b32 s34, 0, s34
    s_lshl_b32 s36, s16, 2
    s_add_u32 s36, s36, s19
    s_lshl_b32 s36, s36, 2
    s_add_u32 s36, s36, s17
    s_lshl_b32 s38, s36, 9
    s_add_u32 s38, s38, 16777216
    buffer_load_dword v12, v13, s[32:35], s38 offen
    s_xor_b32 s37, s36, 1
    s_mul_i32 s37, s37, 9216
    s_add_u32 s37, s37, 0
    buffer_load_dwordx4 v[20:23], v143, s[32:35], s37 offen offset:1024
    buffer_load_dwordx4 v[24:27], v143, s[32:35], s37 offen offset:2048
    s_waitcnt vmcnt(9)
    s_barrier
    s_xor_b32 s37, s36, 2
    s_mul_i32 s37, s37, 9216
    s_add_u32 s37, s37, 3072
    buffer_load_dwordx4 v[20:23], v143, s[32:35], s37 offen offset:1024
    buffer_load_dwordx4 v[24:27], v143, s[32:35], s37 offen offset:2048
    s_waitcnt vmcnt(7)
    s_barrier
    s_xor_b32 s37, s36, 3
    s_mul_i32 s37, s37, 9216
    s_add_u32 s37, s37, 6144
    buffer_load_dwordx4 v[20:23], v143, s[32:35], s37 offen offset:1024
    buffer_load_dwordx4 v[24:27], v143, s[32:35], s37 offen offset:2048
    s_waitcnt vmcnt(7)
    s_barrier
    s_endpgm
L_compute:
    v_and_b32 v100, 7, v142
    v_mul_u32_u24 v100, 1056, v100
    v_bfe_u32 v101, v142, 3, 1
    v_lshlrev_b32 v101, 8, v101
    v_and_b32 v102, 48, v142
    v_add3_u32 v138, v100, v101, v102
    v_bfe_u32 v100, v142, 2, 3
    v_mul_u32_u24 v100, 1056, v100
    v_lshrrev_b32 v101, 5, v142
    v_lshlrev_b32 v101, 8, v101
    v_and_b32 v103, 3, v142
    v_lshlrev_b32 v103, 3, v103
    v_add3_u32 v139, v100, v101, v103
    v_add_u32 v139, 8448, v139
    s_mul_i32 s42, s19, 4608
    s_add_u32 s42, s42, 135168
    v_lshrrev_b32 v103, 4, v142
    v_mul_u32_u24 v105, 288, v103
    v_and_b32 v107, 15, v142
    v_lshlrev_b32 v108, 4, v107
    v_add3_u32 v105, v105, v108, s42
    v_mul_u32_u24 v106, 288, v107
    v_add3_u32 v106, v106, v102, s42
    v_bfe_u32 v107, v142, 2, 2
    v_mul_u32_u24 v107, 1088, v107
    v_and_b32 v109, 3, v142
    v_xor_b32 v110, v109, v103
    v_lshlrev_b32 v110, 4, v110
    v_lshlrev_b32 v109, 8, v109
    v_add3_u32 v107, v107, v109, v110
    v_add_u32 v107, 153600, v107
    v_and_b32 v111, 3, v142
    v_lshlrev_b32 v111, 7, v111
    s_lshl_b32 s46, s16, 9
    s_lshl_b32 s47, s17, 2
    s_add_u32 s46, s46, s47
    s_add_u32 s47, s46, 25165824
    s_cmp_eq_u32 s19, 0
    s_cselect_b32 s63, 2, 99
    v_mov_b32 v142, v108
    v_mov_b32 v128, v105
    v_mov_b32 v129, v106
    v_mov_b32 v130, v107
    v_mov_b32 v132, 0
    v_mov_b32 v133, 0
    v_mov_b32 v134, 0
    v_mov_b32 v135, 0
    v_mov_b32 v136, 0
    v_mov_b32 v137, 0
    s_mov_b32 s52, 0x3e0293ee
    s_mov_b32 s53, 0x3e0293ee
    s_mov_b32 s51, 0xffff0000
    v_add_u32 v140, 118272, v138
    s_mov_b32 s54, 33792
    s_mov_b32 s44, 0
    s_lshl_b32 s40, s36, 2
    s_xor_b32 s42, s17, 1
    s_add_u32 s42, s42, s40
    s_mul_i32 s56, s42, 9216
    s_xor_b32 s42, s17, 2
    s_add_u32 s42, s42, s40
    s_mul_i32 s57, s42, 9216
    s_add_u32 s57, s57, 3072
    s_xor_b32 s42, s17, 3
    s_add_u32 s42, s42, s40
    s_mul_i32 s58, s42, 9216
    s_add_u32 s58, s58, 6144
    s_add_u32 s42, s40, s17
    s_lshl_b32 s59, s42, 9
    s_add_u32 s59, s59, 16777216
    s_mul_i32 s60, s42, 9216
    s_lshl_b32 s61, s36, 7
    s_add_u32 s61, s61, 25165824
    s_lshl_b32 s62, s16, 2
    s_mov_b32 s26, 12288
    s_mov_b32 s30, 0x10000000
    s_mov_b32 s34, 256
    s_mov_b32 s35, 0x20000
    s_mov_b32 s48, 0x3f80
    s_mov_b32 s49, 0x3f800000
    s_add_u32 s24, s10, s37
    s_addc_u32 s25, s11, 0
    s_mov_b32 s28, s14
    s_mov_b32 s29, s15
    s_mov_b32 s32, s12
    s_mov_b32 s33, s13
    s_waitcnt vmcnt(11)
    v_lshlrev_b32 v112, 16, v4
    v_and_b32 v113, s51, v4
    v_lshlrev_b32 v114, 16, v5
    v_and_b32 v115, s51, v5
    v_lshlrev_b32 v116, 16, v6
    v_and_b32 v117, s51, v6
    v_lshlrev_b32 v118, 16, v7
    v_and_b32 v119, s51, v7
    v_pk_mul_f32 v[112:113], v[112:113], s[52:53]
    v_pk_mul_f32 v[114:115], v[114:115], s[52:53]
    v_pk_mul_f32 v[116:117], v[116:117], s[52:53]
    v_pk_mul_f32 v[118:119], v[118:119], s[52:53]
    v_cvt_pk_bf16_f32 v4, v112, v113
    v_cvt_pk_bf16_f32 v5, v114, v115
    v_cvt_pk_bf16_f32 v6, v116, v117
    v_cvt_pk_bf16_f32 v7, v118, v119
    ds_write_b128 v128, v[4:7] offset:0
    s_waitcnt vmcnt(10)
    v_lshlrev_b32 v112, 16, v16
    v_and_b32 v113, s51, v16
    v_lshlrev_b32 v114, 16, v17
    v_and_b32 v115, s51, v17
    v_lshlrev_b32 v116, 16, v18
    v_and_b32 v117, s51, v18
    v_lshlrev_b32 v118, 16, v19
    v_and_b32 v119, s51, v19
    v_pk_mul_f32 v[112:113], v[112:113], s[52:53]
    v_pk_mul_f32 v[114:115], v[114:115], s[52:53]
    v_pk_mul_f32 v[116:117], v[116:117], s[52:53]
    v_pk_mul_f32 v[118:119], v[118:119], s[52:53]
    v_cvt_pk_bf16_f32 v16, v112, v113
    v_cvt_pk_bf16_f32 v17, v114, v115
    v_cvt_pk_bf16_f32 v18, v116, v117
    v_cvt_pk_bf16_f32 v19, v118, v119
    ds_write_b128 v128, v[16:19] offset:1152
    s_waitcnt vmcnt(9)
    v_lshlrev_b32 v112, 16, v28
    v_and_b32 v113, s51, v28
    v_lshlrev_b32 v114, 16, v29
    v_and_b32 v115, s51, v29
    v_lshlrev_b32 v116, 16, v30
    v_and_b32 v117, s51, v30
    v_lshlrev_b32 v118, 16, v31
    v_and_b32 v119, s51, v31
    v_pk_mul_f32 v[112:113], v[112:113], s[52:53]
    v_pk_mul_f32 v[114:115], v[114:115], s[52:53]
    v_pk_mul_f32 v[116:117], v[116:117], s[52:53]
    v_pk_mul_f32 v[118:119], v[118:119], s[52:53]
    v_cvt_pk_bf16_f32 v28, v112, v113
    v_cvt_pk_bf16_f32 v29, v114, v115
    v_cvt_pk_bf16_f32 v30, v116, v117
    v_cvt_pk_bf16_f32 v31, v118, v119
    ds_write_b128 v128, v[28:31] offset:2304
    s_waitcnt vmcnt(8)
    v_lshlrev_b32 v112, 16, v40
    v_and_b32 v113, s51, v40
    v_lshlrev_b32 v114, 16, v41
    v_and_b32 v115, s51, v41
    v_lshlrev_b32 v116, 16, v42
    v_and_b32 v117, s51, v42
    v_lshlrev_b32 v118, 16, v43
    v_and_b32 v119, s51, v43
    v_pk_mul_f32 v[112:113], v[112:113], s[52:53]
    v_pk_mul_f32 v[114:115], v[114:115], s[52:53]
    v_pk_mul_f32 v[116:117], v[116:117], s[52:53]
    v_pk_mul_f32 v[118:119], v[118:119], s[52:53]
    v_cvt_pk_bf16_f32 v40, v112, v113
    v_cvt_pk_bf16_f32 v41, v114, v115
    v_cvt_pk_bf16_f32 v42, v116, v117
    v_cvt_pk_bf16_f32 v43, v118, v119
    ds_write_b128 v128, v[40:43] offset:3456
    ds_read_b128 a[0:3], v129 offset:0
    ds_read_b128 a[4:7], v129 offset:64
    ds_read_b128 a[8:11], v129 offset:128
    ds_read_b128 a[12:15], v129 offset:192
L_ba:
    s_barrier
    ds_read_b128 v[52:55], v130 offset:0
    ds_read_b128 v[64:67], v130 offset:64
    ds_read_b128 v[76:79], v130 offset:128
    ds_read_b128 v[88:91], v130 offset:192
    ds_read_b128 a[48:51], v140 offset:0
    ds_read_b128 a[52:55], v140 offset:64
    ds_read_b128 a[56:59], v140 offset:128
    ds_read_b128 a[60:63], v140 offset:192
    ds_read_b128 a[64:67], v140 offset:512
    ds_read_b128 a[68:71], v140 offset:576
    ds_read_b128 a[72:75], v140 offset:640
    ds_read_b128 a[76:79], v140 offset:704
    s_waitcnt vmcnt(7)
    v_lshlrev_b32 v112, 16, v8
    v_and_b32 v113, s51, v8
    v_lshlrev_b32 v114, 16, v9
    v_and_b32 v115, s51, v9
    v_lshlrev_b32 v116, 16, v10
    v_and_b32 v117, s51, v10
    v_lshlrev_b32 v118, 16, v11
    v_and_b32 v119, s51, v11
    v_mul_f32 v112, s52, v112
    v_mul_f32 v113, s52, v113
    v_mul_f32 v114, s52, v114
    v_mul_f32 v115, s52, v115
    v_mul_f32 v116, s52, v116
    v_mul_f32 v117, s52, v117
    v_mul_f32 v118, s52, v118
    v_mul_f32 v119, s52, v119
    v_cvt_pk_bf16_f32 v8, v112, v113
    v_cvt_pk_bf16_f32 v9, v114, v115
    v_cvt_pk_bf16_f32 v10, v116, v117
    v_cvt_pk_bf16_f32 v11, v118, v119
    ds_write_b128 v128, v[8:11] offset:0
    s_waitcnt lgkmcnt(1)
    v_mfma_f32_16x16x32_bf16 v[120:123], v[52:55], a[0:3], 0
    s_waitcnt vmcnt(6)
    v_lshlrev_b32 v112, 16, v20
    v_and_b32 v113, s51, v20
    v_lshlrev_b32 v114, 16, v21
    v_and_b32 v115, s51, v21
    v_lshlrev_b32 v116, 16, v22
    v_mfma_f32_16x16x32_bf16 v[120:123], v[64:67], a[4:7], v[120:123]
    v_and_b32 v117, s51, v22
    v_lshlrev_b32 v118, 16, v23
    v_and_b32 v119, s51, v23
    v_mul_f32 v112, s52, v112
    v_mul_f32 v113, s52, v113
    v_mul_f32 v114, s52, v114
    v_mul_f32 v115, s52, v115
    v_mfma_f32_16x16x32_bf16 v[120:123], v[76:79], a[8:11], v[120:123]
    v_mul_f32 v116, s52, v116
    v_mul_f32 v117, s52, v117
    v_mul_f32 v118, s52, v118
    v_mul_f32 v119, s52, v119
    v_cvt_pk_bf16_f32 v20, v112, v113
    v_cvt_pk_bf16_f32 v21, v114, v115
    v_cvt_pk_bf16_f32 v22, v116, v117
    v_mfma_f32_16x16x32_bf16 v[120:123], v[88:91], a[12:15], v[120:123]
    v_cvt_pk_bf16_f32 v23, v118, v119
    ds_write_b128 v128, v[20:23] offset:1152
    s_waitcnt vmcnt(5)
    v_lshlrev_b32 v112, 16, v32
    v_and_b32 v113, s51, v32
    v_lshlrev_b32 v114, 16, v33
    v_and_b32 v115, s51, v33
    v_mfma_f32_16x16x32_bf16 v[96:99], a[48:51], a[0:3], 0
    v_lshlrev_b32 v116, 16, v34
    v_and_b32 v117, s51, v34
    v_lshlrev_b32 v118, 16, v35
    v_and_b32 v119, s51, v35
    v_mul_f32 v112, s52, v112
    v_mul_f32 v113, s52, v113
    v_mul_f32 v114, s52, v114
    v_mfma_f32_16x16x32_bf16 v[96:99], a[52:55], a[4:7], v[96:99]
    v_mul_f32 v115, s52, v115
    v_mul_f32 v116, s52, v116
    v_mul_f32 v117, s52, v117
    v_mul_f32 v118, s52, v118
    v_mul_f32 v119, s52, v119
    v_cvt_pk_bf16_f32 v32, v112, v113
    v_cvt_pk_bf16_f32 v33, v114, v115
    v_mfma_f32_16x16x32_bf16 v[96:99], a[56:59], a[8:11], v[96:99]
    v_cvt_pk_bf16_f32 v34, v116, v117
    v_cvt_pk_bf16_f32 v35, v118, v119
    ds_write_b128 v128, v[32:35] offset:2304
    s_waitcnt vmcnt(4)
    v_lshlrev_b32 v112, 16, v44
    v_and_b32 v113, s51, v44
    v_mfma_f32_16x16x32_bf16 v[96:99], a[60:63], a[12:15], v[96:99]
    v_lshlrev_b32 v114, 16, v45
    v_and_b32 v115, s51, v45
    v_lshlrev_b32 v116, 16, v46
    v_and_b32 v117, s51, v46
    v_lshlrev_b32 v118, 16, v47
    v_and_b32 v119, s51, v47
    v_mul_f32 v112, s52, v112
    v_mfma_f32_16x16x32_bf16 v[100:103], a[64:67], a[0:3], 0
    v_mul_f32 v113, s52, v113
    v_mul_f32 v114, s52, v114
    v_mul_f32 v115, s52, v115
    v_mul_f32 v116, s52, v116
    v_mul_f32 v117, s52, v117
    v_mul_f32 v118, s52, v118
    v_mul_f32 v119, s52, v119
    v_mfma_f32_16x16x32_bf16 v[100:103], a[68:71], a[4:7], v[100:103]
    v_cvt_pk_bf16_f32 v44, v112, v113
    v_cvt_pk_bf16_f32 v45, v114, v115
    v_cvt_pk_bf16_f32 v46, v116, v117
    v_cvt_pk_bf16_f32 v47, v118, v119
    ds_write_b128 v128, v[44:47] offset:3456
    ds_read_b128 a[16:19], v129 offset:0
    ds_read_b128 a[20:23], v129 offset:64
    v_mfma_f32_16x16x32_bf16 v[100:103], a[72:75], a[8:11], v[100:103]
    ds_read_b128 a[24:27], v129 offset:128
    ds_read_b128 a[28:31], v129 offset:192
    v_max3_f32 v120, v120, v121, v122
    v_max_f32 v120, v120, v123
    v_mov_b32 v121, v120
    s_nop 1
    v_permlane32_swap_b32 v120, v121
    v_mfma_f32_16x16x32_bf16 v[100:103], a[76:79], a[12:15], v[100:103]
    s_nop 1
    v_max_f32 v120, v120, v121
    v_mov_b32 v121, v120
    s_nop 1
    v_permlane16_swap_b32 v120, v121
    s_nop 1
    v_max_f32 v120, v120, v121
    v_sub_f32 v96, v96, v120
    v_sub_f32 v97, v97, v120
    v_sub_f32 v98, v98, v120
    v_sub_f32 v99, v99, v120
    v_sub_f32 v100, v100, v120
    v_sub_f32 v101, v101, v120
    v_sub_f32 v102, v102, v120
    v_sub_f32 v103, v103, v120
    s_waitcnt lgkmcnt(0)
    v_mfma_f32_16x16x32_bf16 v[124:127], v[52:55], a[16:19], 0
    v_exp_f32 v96, v96
    v_exp_f32 v97, v97
    v_exp_f32 v98, v98
    v_mfma_f32_16x16x32_bf16 v[124:127], v[64:67], a[20:23], v[124:127]
    v_cvt_pk_bf16_f32 v112, v96, v97
    v_add_f32 v132, v132, v96
    v_exp_f32 v99, v99
    v_exp_f32 v100, v100
    v_mfma_f32_16x16x32_bf16 v[124:127], v[76:79], a[24:27], v[124:127]
    v_cvt_pk_bf16_f32 v113, v98, v99
    v_add_f32 v133, v133, v97
    v_add_f32 v132, v132, v98
    v_mfma_f32_16x16x32_bf16 v[124:127], v[88:91], a[28:31], v[124:127]
    v_add_f32 v133, v133, v99
    v_exp_f32 v101, v101
    v_exp_f32 v102, v102
    v_cvt_pk_bf16_f32 v114, v100, v101
    v_mfma_f32_16x16x32_bf16 v[104:107], a[48:51], a[16:19], 0
    v_add_f32 v132, v132, v100
    v_exp_f32 v103, v103
    v_add_f32 v133, v133, v101
    v_mfma_f32_16x16x32_bf16 v[104:107], a[52:55], a[20:23], v[104:107]
    v_add_f32 v132, v132, v102
    v_cvt_pk_bf16_f32 v115, v102, v103
    v_add_f32 v133, v133, v103
    s_waitcnt vmcnt(3)
    v_mfma_f32_16x16x32_bf16 v[104:107], a[56:59], a[24:27], v[104:107]
    v_lshlrev_b32 v4, 16, v56
    v_and_b32 v5, s51, v56
    v_lshlrev_b32 v6, 16, v57
    v_mfma_f32_16x16x32_bf16 v[104:107], a[60:63], a[28:31], v[104:107]
    v_and_b32 v7, s51, v57
    v_lshlrev_b32 v16, 16, v58
    v_and_b32 v17, s51, v58
    v_lshlrev_b32 v18, 16, v59
    v_mfma_f32_16x16x32_bf16 v[108:111], a[64:67], a[16:19], 0
    v_and_b32 v19, s51, v59
    v_mul_f32 v4, s52, v4
    v_mul_f32 v5, s52, v5
    v_mfma_f32_16x16x32_bf16 v[108:111], a[68:71], a[20:23], v[108:111]
    v_mul_f32 v6, s52, v6
    v_mul_f32 v7, s52, v7
    v_mul_f32 v16, s52, v16
    v_mul_f32 v17, s52, v17
    v_mfma_f32_16x16x32_bf16 v[108:111], a[72:75], a[24:27], v[108:111]
    v_mul_f32 v18, s52, v18
    v_mul_f32 v19, s52, v19
    v_cvt_pk_bf16_f32 v56, v4, v5
    v_mfma_f32_16x16x32_bf16 v[108:111], a[76:79], a[28:31], v[108:111]
    v_cvt_pk_bf16_f32 v57, v6, v7
    v_cvt_pk_bf16_f32 v58, v16, v17
    v_cvt_pk_bf16_f32 v59, v18, v19
    ds_write_b128 v128, v[56:59] offset:0
    s_barrier
    ds_read_b64_tr_b16 a[80:81], v139 offset:0
    ds_read_b64_tr_b16 a[82:83], v139 offset:512
    ds_read_b64_tr_b16 a[84:85], v139 offset:32
    ds_read_b64_tr_b16 a[86:87], v139 offset:544
    ds_read_b64_tr_b16 a[88:89], v139 offset:64
    ds_read_b64_tr_b16 a[90:91], v139 offset:576
    ds_read_b64_tr_b16 a[92:93], v139 offset:96
    ds_read_b64_tr_b16 a[94:95], v139 offset:608
    ds_read_b64_tr_b16 a[96:97], v139 offset:128
    ds_read_b64_tr_b16 a[98:99], v139 offset:640
    ds_read_b64_tr_b16 a[100:101], v139 offset:160
    ds_read_b64_tr_b16 a[102:103], v139 offset:672
    ds_read_b64_tr_b16 a[104:105], v139 offset:192
    ds_read_b64_tr_b16 a[106:107], v139 offset:704
    ds_read_b64_tr_b16 a[108:109], v139 offset:224
    ds_read_b64_tr_b16 a[110:111], v139 offset:736
    s_waitcnt vmcnt(2)
    v_lshlrev_b32 v4, 16, v68
    v_and_b32 v5, s51, v68
    v_lshlrev_b32 v6, 16, v69
    v_and_b32 v7, s51, v69
    v_lshlrev_b32 v16, 16, v70
    v_and_b32 v17, s51, v70
    v_lshlrev_b32 v18, 16, v71
    v_and_b32 v19, s51, v71
    v_mul_f32 v4, s52, v4
    v_mul_f32 v5, s52, v5
    v_mul_f32 v6, s52, v6
    v_mul_f32 v7, s52, v7
    v_mul_f32 v16, s52, v16
    v_mul_f32 v17, s52, v17
    v_mul_f32 v18, s52, v18
    v_mul_f32 v19, s52, v19
    v_cvt_pk_bf16_f32 v68, v4, v5
    v_cvt_pk_bf16_f32 v69, v6, v7
    v_cvt_pk_bf16_f32 v70, v16, v17
    v_cvt_pk_bf16_f32 v71, v18, v19
    ds_write_b128 v128, v[68:71] offset:1152
    s_waitcnt lgkmcnt(9)
    v_mfma_f32_16x16x32_bf16 v[0:3], a[80:83], v[112:115], 0
    s_waitcnt vmcnt(1)
    v_lshlrev_b32 v4, 16, v80
    v_and_b32 v5, s51, v80
    v_lshlrev_b32 v6, 16, v81
    v_and_b32 v7, s51, v81
    v_mfma_f32_16x16x32_bf16 v[12:15], a[84:87], v[112:115], 0
    v_lshlrev_b32 v16, 16, v82
    v_and_b32 v17, s51, v82
    v_lshlrev_b32 v18, 16, v83
    v_and_b32 v19, s51, v83
    v_mul_f32 v4, s52, v4
    v_mul_f32 v5, s52, v5
    v_mfma_f32_16x16x32_bf16 v[24:27], a[88:91], v[112:115], 0
    v_mul_f32 v6, s52, v6
    v_mul_f32 v7, s52, v7
    v_mul_f32 v16, s52, v16
    v_mul_f32 v17, s52, v17
    v_mul_f32 v18, s52, v18
    v_mfma_f32_16x16x32_bf16 v[36:39], a[92:95], v[112:115], 0
    v_mul_f32 v19, s52, v19
    v_cvt_pk_bf16_f32 v80, v4, v5
    v_cvt_pk_bf16_f32 v81, v6, v7
    v_cvt_pk_bf16_f32 v82, v16, v17
    v_cvt_pk_bf16_f32 v83, v18, v19
    ds_write_b128 v128, v[80:83] offset:2304
    s_waitcnt lgkmcnt(2)
    v_mfma_f32_16x16x32_bf16 v[48:51], a[96:99], v[112:115], 0
    s_waitcnt vmcnt(0)
    v_lshlrev_b32 v4, 16, v92
    v_and_b32 v5, s51, v92
    v_lshlrev_b32 v6, 16, v93
    v_and_b32 v7, s51, v93
    v_lshlrev_b32 v16, 16, v94
    v_and_b32 v17, s51, v94
    v_lshlrev_b32 v18, 16, v95
    v_and_b32 v19, s51, v95
    v_mfma_f32_16x16x32_bf16 v[60:63], a[100:103], v[112:115], 0
    v_mul_f32 v4, s52, v4
    v_mul_f32 v5, s52, v5
    v_mul_f32 v6, s52, v6
    v_mul_f32 v7, s52, v7
    v_mul_f32 v16, s52, v16
    v_mul_f32 v17, s52, v17
    v_mul_f32 v18, s52, v18
    v_mul_f32 v19, s52, v19
    v_cvt_pk_bf16_f32 v92, v4, v5
    v_cvt_pk_bf16_f32 v93, v6, v7
    v_mfma_f32_16x16x32_bf16 v[72:75], a[104:107], v[112:115], 0
    v_cvt_pk_bf16_f32 v94, v16, v17
    v_cvt_pk_bf16_f32 v95, v18, v19
    ds_write_b128 v128, v[92:95] offset:3456
    ds_read_b128 a[32:35], v129 offset:0
    ds_read_b128 a[36:39], v129 offset:64
    ds_read_b128 a[40:43], v129 offset:128
    ds_read_b128 a[44:47], v129 offset:192
    v_max3_f32 v124, v124, v125, v126
    v_max_f32 v124, v124, v127
    v_mfma_f32_16x16x32_bf16 v[84:87], a[108:111], v[112:115], 0
    v_mov_b32 v125, v124
    s_nop 1
    v_permlane32_swap_b32 v124, v125
    s_nop 1
    v_max_f32 v124, v124, v125
    v_mov_b32 v125, v124
    s_nop 1
    v_permlane16_swap_b32 v124, v125
    s_nop 1
    v_max_f32 v124, v124, v125
    v_sub_f32 v104, v104, v124
    v_sub_f32 v105, v105, v124
    v_sub_f32 v106, v106, v124
    v_sub_f32 v107, v107, v124
    v_sub_f32 v108, v108, v124
    v_sub_f32 v109, v109, v124
    v_sub_f32 v110, v110, v124
    v_sub_f32 v111, v111, v124
    s_waitcnt lgkmcnt(0)
    v_mfma_f32_16x16x32_bf16 v[128:131], v[52:55], a[32:35], 0
    v_exp_f32 v104, v104
    v_exp_f32 v105, v105
    v_mfma_f32_16x16x32_bf16 v[128:131], v[64:67], a[36:39], v[128:131]
    v_exp_f32 v106, v106
    v_cvt_pk_bf16_f32 v116, v104, v105
    v_mfma_f32_16x16x32_bf16 v[128:131], v[76:79], a[40:43], v[128:131]
    v_add_f32 v134, v134, v104
    v_exp_f32 v107, v107
    v_exp_f32 v108, v108
    v_mfma_f32_16x16x32_bf16 v[128:131], v[88:91], a[44:47], v[128:131]
    v_cvt_pk_bf16_f32 v117, v106, v107
    v_add_f32 v135, v135, v105
    v_mfma_f32_16x16x32_bf16 v[96:99], a[48:51], a[32:35], 0
    ds_read_b128 a[48:51], v138 offset:0
    v_add_f32 v134, v134, v106
    v_add_f32 v135, v135, v107
    v_mfma_f32_16x16x32_bf16 v[96:99], a[52:55], a[36:39], v[96:99]
    ds_read_b128 a[52:55], v138 offset:64
    v_exp_f32 v109, v109
    v_exp_f32 v110, v110
    v_cvt_pk_bf16_f32 v118, v108, v109
    v_mfma_f32_16x16x32_bf16 v[96:99], a[56:59], a[40:43], v[96:99]
    ds_read_b128 a[56:59], v138 offset:128
    v_add_f32 v134, v134, v108
    v_exp_f32 v111, v111
    v_mfma_f32_16x16x32_bf16 v[96:99], a[60:63], a[44:47], v[96:99]
    ds_read_b128 a[60:63], v138 offset:192
    v_add_f32 v135, v135, v109
    v_add_f32 v134, v134, v110
    v_mfma_f32_16x16x32_bf16 v[100:103], a[64:67], a[32:35], 0
    ds_read_b128 a[64:67], v138 offset:512
    v_cvt_pk_bf16_f32 v119, v110, v111
    v_add_f32 v135, v135, v111
    v_sub_f32 v121, 0, v120
    v_mfma_f32_16x16x32_bf16 v[100:103], a[68:71], a[36:39], v[100:103]
    ds_read_b128 a[68:71], v138 offset:576
    v_sub_f32 v122, 0, v120
    v_sub_f32 v123, 0, v120
    v_mfma_f32_16x16x32_bf16 v[100:103], a[72:75], a[40:43], v[100:103]
    ds_read_b128 a[72:75], v138 offset:640
    v_sub_f32 v120, 0, v120
    v_sub_f32 v125, 0, v124
    v_mfma_f32_16x16x32_bf16 v[100:103], a[76:79], a[44:47], v[100:103]
    ds_read_b128 a[76:79], v138 offset:704
    v_sub_f32 v126, 0, v124
    v_sub_f32 v127, 0, v124
    v_sub_f32 v124, 0, v124
    v_mfma_f32_16x16x32_bf16 v[4:7], a[80:83], v[116:119], 0
    v_max3_f32 v128, v128, v129, v130
    v_max_f32 v128, v128, v131
    v_mov_b32 v129, v128
    s_nop 1
    v_mfma_f32_16x16x32_bf16 v[16:19], a[84:87], v[116:119], 0
    v_permlane32_swap_b32 v128, v129
    s_nop 1
    v_max_f32 v128, v128, v129
    v_mov_b32 v129, v128
    v_mfma_f32_16x16x32_bf16 v[28:31], a[88:91], v[116:119], 0
    s_nop 1
    v_permlane16_swap_b32 v128, v129
    s_nop 1
    v_max_f32 v128, v128, v129
    v_sub_f32 v96, v96, v128
    v_mfma_f32_16x16x32_bf16 v[40:43], a[92:95], v[116:119], 0
    v_sub_f32 v97, v97, v128
    v_sub_f32 v98, v98, v128
    v_sub_f32 v99, v99, v128
    v_sub_f32 v100, v100, v128
    v_mfma_f32_16x16x32_bf16 v[52:55], a[96:99], v[116:119], 0
    v_sub_f32 v101, v101, v128
    v_sub_f32 v102, v102, v128
    v_sub_f32 v103, v103, v128
    v_exp_f32 v96, v96
    v_mfma_f32_16x16x32_bf16 v[64:67], a[100:103], v[116:119], 0
    v_exp_f32 v97, v97
    v_exp_f32 v98, v98
    v_cvt_pk_bf16_f32 v112, v96, v97
    v_add_f32 v136, v136, v96
    v_exp_f32 v99, v99
    v_mfma_f32_16x16x32_bf16 v[76:79], a[104:107], v[116:119], 0
    v_exp_f32 v100, v100
    v_cvt_pk_bf16_f32 v113, v98, v99
    v_add_f32 v137, v137, v97
    v_add_f32 v136, v136, v98
    v_mfma_f32_16x16x32_bf16 v[88:91], a[108:111], v[116:119], 0
    v_add_f32 v137, v137, v99
    v_sub_f32 v129, 0, v128
    v_sub_f32 v130, 0, v128
    v_sub_f32 v131, 0, v128
    v_sub_f32 v128, 0, v128
    v_mov_b32 v8, v120
    v_mov_b32 v9, v124
    v_mov_b32 v10, v128
    buffer_store_dwordx4 v[8:11], v142, s[28:31], s59 offen offset:256 sc1
    s_waitcnt lgkmcnt(4)
    v_mfma_f32_16x16x32_bf16 v[104:107], a[48:51], a[0:3], v[120:123]
    v_mfma_f32_16x16x32_bf16 v[104:107], a[52:55], a[4:7], v[104:107]
    v_mfma_f32_16x16x32_bf16 v[104:107], a[56:59], a[8:11], v[104:107]
    v_mfma_f32_16x16x32_bf16 v[104:107], a[60:63], a[12:15], v[104:107]
    s_waitcnt lgkmcnt(0)
    v_mfma_f32_16x16x32_bf16 v[108:111], a[64:67], a[0:3], v[120:123]
    v_mfma_f32_16x16x32_bf16 v[108:111], a[68:71], a[4:7], v[108:111]
    v_mfma_f32_16x16x32_bf16 v[108:111], a[72:75], a[8:11], v[108:111]
    v_mfma_f32_16x16x32_bf16 v[108:111], a[76:79], a[12:15], v[108:111]
    v_exp_f32 v101, v101
    v_exp_f32 v102, v102
    v_cvt_pk_bf16_f32 v114, v100, v101
    v_add_f32 v136, v136, v100
    v_exp_f32 v103, v103
    v_add_f32 v137, v137, v101
    v_add_f32 v136, v136, v102
    v_cvt_pk_bf16_f32 v115, v102, v103
    v_add_f32 v137, v137, v103
    s_barrier
    v_mfma_f32_16x16x32_bf16 v[8:11], a[80:83], v[112:115], 0
    v_mfma_f32_16x16x32_bf16 v[20:23], a[84:87], v[112:115], 0
    v_mfma_f32_16x16x32_bf16 v[32:35], a[88:91], v[112:115], 0
    v_mfma_f32_16x16x32_bf16 v[44:47], a[92:95], v[112:115], 0
    v_mfma_f32_16x16x32_bf16 v[56:59], a[96:99], v[112:115], 0
    v_mfma_f32_16x16x32_bf16 v[68:71], a[100:103], v[112:115], 0
    v_mfma_f32_16x16x32_bf16 v[80:83], a[104:107], v[112:115], 0
    v_mfma_f32_16x16x32_bf16 v[92:95], a[108:111], v[112:115], 0
    v_exp_f32 v104, v104
    ds_read_b64_tr_b16 a[80:81], v139 offset:16896
    v_exp_f32 v105, v105
    ds_read_b64_tr_b16 a[82:83], v139 offset:17408
    v_exp_f32 v106, v106
    ds_read_b64_tr_b16 a[84:85], v139 offset:16928
    v_cvt_pk_bf16_f32 v116, v104, v105
    v_add_f32 v132, v132, v104
    ds_read_b64_tr_b16 a[86:87], v139 offset:17440
    v_exp_f32 v107, v107
    ds_read_b64_tr_b16 a[88:89], v139 offset:16960
    v_exp_f32 v108, v108
    ds_read_b64_tr_b16 a[90:91], v139 offset:17472
    v_cvt_pk_bf16_f32 v117, v106, v107
    v_add_f32 v133, v133, v105
    ds_read_b64_tr_b16 a[92:93], v139 offset:16992
    v_add_f32 v132, v132, v106
    v_add_f32 v133, v133, v107
    ds_read_b64_tr_b16 a[94:95], v139 offset:17504
    s_branch L_k3
L_loop0:
    v_mfma_f32_16x16x32_bf16 v[104:107], a[48:51], a[32:35], v[128:131]
    v_mfma_f32_16x16x32_bf16 v[104:107], a[52:55], a[36:39], v[104:107]
    v_mfma_f32_16x16x32_bf16 v[104:107], a[56:59], a[40:43], v[104:107]
    v_mfma_f32_16x16x32_bf16 v[104:107], a[60:63], a[44:47], v[104:107]
    v_mfma_f32_16x16x32_bf16 v[108:111], a[64:67], a[32:35], v[128:131]
    v_mfma_f32_16x16x32_bf16 v[108:111], a[68:71], a[36:39], v[108:111]
    v_mfma_f32_16x16x32_bf16 v[108:111], a[72:75], a[40:43], v[108:111]
    v_mfma_f32_16x16x32_bf16 v[108:111], a[76:79], a[44:47], v[108:111]
    v_exp_f32 v101, v101
    v_exp_f32 v102, v102
    v_cvt_pk_bf16_f32 v114, v100, v101
    v_add_f32 v134, v134, v100
    v_exp_f32 v103, v103
    v_add_f32 v135, v135, v101
    v_add_f32 v134, v134, v102
    v_cvt_pk_bf16_f32 v115, v102, v103
    v_add_f32 v135, v135, v103
    ds_read_b128 a[48:51], v138 offset:16896
    ds_read_b128 a[52:55], v138 offset:16960
    ds_read_b128 a[56:59], v138 offset:17024
    ds_read_b128 a[60:63], v138 offset:17088
    v_mfma_f32_16x16x32_bf16 v[4:7], a[80:83], v[112:115], v[4:7]
    v_mfma_f32_16x16x32_bf16 v[16:19], a[84:87], v[112:115], v[16:19]
    v_mfma_f32_16x16x32_bf16 v[28:31], a[88:91], v[112:115], v[28:31]
    v_mfma_f32_16x16x32_bf16 v[40:43], a[92:95], v[112:115], v[40:43]
    v_mfma_f32_16x16x32_bf16 v[52:55], a[96:99], v[112:115], v[52:55]
    v_mfma_f32_16x16x32_bf16 v[64:67], a[100:103], v[112:115], v[64:67]
    v_mfma_f32_16x16x32_bf16 v[76:79], a[104:107], v[112:115], v[76:79]
    v_mfma_f32_16x16x32_bf16 v[88:91], a[108:111], v[112:115], v[88:91]
    v_exp_f32 v104, v104
    v_exp_f32 v105, v105
    ds_read_b128 a[64:67], v138 offset:17408
    v_exp_f32 v106, v106
    ds_read_b128 a[68:71], v138 offset:17472
    v_cvt_pk_bf16_f32 v116, v104, v105
    v_add_f32 v136, v136, v104
    v_exp_f32 v107, v107
    ds_read_b128 a[72:75], v138 offset:17536
    v_exp_f32 v108, v108
    v_cvt_pk_bf16_f32 v117, v106, v107
    v_add_f32 v137, v137, v105
    v_add_f32 v136, v136, v106
    v_add_f32 v137, v137, v107
    ds_read_b128 a[76:79], v138 offset:17600
    s_waitcnt lgkmcnt(4)
    v_mfma_f32_16x16x32_bf16 v[96:99], a[48:51], a[0:3], v[120:123]
    v_mfma_f32_16x16x32_bf16 v[96:99], a[52:55], a[4:7], v[96:99]
    v_mfma_f32_16x16x32_bf16 v[96:99], a[56:59], a[8:11], v[96:99]
    v_mfma_f32_16x16x32_bf16 v[96:99], a[60:63], a[12:15], v[96:99]
    s_waitcnt lgkmcnt(0)
    v_mfma_f32_16x16x32_bf16 v[100:103], a[64:67], a[0:3], v[120:123]
    v_mfma_f32_16x16x32_bf16 v[100:103], a[68:71], a[4:7], v[100:103]
    v_mfma_f32_16x16x32_bf16 v[100:103], a[72:75], a[8:11], v[100:103]
    v_mfma_f32_16x16x32_bf16 v[100:103], a[76:79], a[12:15], v[100:103]
    v_exp_f32 v109, v109
    v_exp_f32 v110, v110
    v_cvt_pk_bf16_f32 v118, v108, v109
    v_add_f32 v136, v136, v108
    v_exp_f32 v111, v111
    v_add_f32 v137, v137, v109
    v_add_f32 v136, v136, v110
    v_cvt_pk_bf16_f32 v119, v110, v111
    v_add_f32 v137, v137, v111
    v_add_u32 v139, s45, v139
    v_add_u32 v138, s45, v138
    s_barrier
    v_mfma_f32_16x16x32_bf16 v[8:11], a[80:83], v[116:119], v[8:11]
    v_mfma_f32_16x16x32_bf16 v[20:23], a[84:87], v[116:119], v[20:23]
    v_mfma_f32_16x16x32_bf16 v[32:35], a[88:91], v[116:119], v[32:35]
    v_mfma_f32_16x16x32_bf16 v[44:47], a[92:95], v[116:119], v[44:47]
    v_mfma_f32_16x16x32_bf16 v[56:59], a[96:99], v[116:119], v[56:59]
    v_mfma_f32_16x16x32_bf16 v[68:71], a[100:103], v[116:119], v[68:71]
    v_mfma_f32_16x16x32_bf16 v[80:83], a[104:107], v[116:119], v[80:83]
    v_mfma_f32_16x16x32_bf16 v[92:95], a[108:111], v[116:119], v[92:95]
    v_exp_f32 v96, v96
    ds_read_b64_tr_b16 a[80:81], v139 offset:0
    v_exp_f32 v97, v97
    ds_read_b64_tr_b16 a[82:83], v139 offset:512
    v_exp_f32 v98, v98
    ds_read_b64_tr_b16 a[84:85], v139 offset:32
    v_cvt_pk_bf16_f32 v112, v96, v97
    v_add_f32 v132, v132, v96
    ds_read_b64_tr_b16 a[86:87], v139 offset:544
    v_exp_f32 v99, v99
    ds_read_b64_tr_b16 a[88:89], v139 offset:64
    v_exp_f32 v100, v100
    ds_read_b64_tr_b16 a[90:91], v139 offset:576
    v_cvt_pk_bf16_f32 v113, v98, v99
    v_add_f32 v133, v133, v97
    ds_read_b64_tr_b16 a[92:93], v139 offset:96
    v_add_f32 v132, v132, v98
    v_add_f32 v133, v133, v99
    ds_read_b64_tr_b16 a[94:95], v139 offset:608
L_k0:
    v_mfma_f32_16x16x32_bf16 v[104:107], a[48:51], a[16:19], v[124:127]
    v_mfma_f32_16x16x32_bf16 v[104:107], a[52:55], a[20:23], v[104:107]
    v_mfma_f32_16x16x32_bf16 v[104:107], a[56:59], a[24:27], v[104:107]
    v_mfma_f32_16x16x32_bf16 v[104:107], a[60:63], a[28:31], v[104:107]
    v_mfma_f32_16x16x32_bf16 v[108:111], a[64:67], a[16:19], v[124:127]
    v_mfma_f32_16x16x32_bf16 v[108:111], a[68:71], a[20:23], v[108:111]
    v_mfma_f32_16x16x32_bf16 v[108:111], a[72:75], a[24:27], v[108:111]
    v_mfma_f32_16x16x32_bf16 v[108:111], a[76:79], a[28:31], v[108:111]
    v_exp_f32 v101, v101
    ds_read_b64_tr_b16 a[96:97], v139 offset:128
    v_exp_f32 v102, v102
    ds_read_b64_tr_b16 a[98:99], v139 offset:640
    v_cvt_pk_bf16_f32 v114, v100, v101
    v_add_f32 v132, v132, v100
    ds_read_b64_tr_b16 a[100:101], v139 offset:160
    v_exp_f32 v103, v103
    ds_read_b64_tr_b16 a[102:103], v139 offset:672
    v_add_f32 v133, v133, v101
    v_add_f32 v132, v132, v102
    ds_read_b64_tr_b16 a[104:105], v139 offset:192
    v_cvt_pk_bf16_f32 v115, v102, v103
    v_add_f32 v133, v133, v103
    ds_read_b64_tr_b16 a[106:107], v139 offset:704
    ds_read_b64_tr_b16 a[108:109], v139 offset:224
    ds_read_b64_tr_b16 a[110:111], v139 offset:736
    s_waitcnt lgkmcnt(8)
    v_mfma_f32_16x16x32_bf16 v[0:3], a[80:83], v[112:115], v[0:3]
    v_mfma_f32_16x16x32_bf16 v[12:15], a[84:87], v[112:115], v[12:15]
    v_mfma_f32_16x16x32_bf16 v[24:27], a[88:91], v[112:115], v[24:27]
    v_mfma_f32_16x16x32_bf16 v[36:39], a[92:95], v[112:115], v[36:39]
    s_waitcnt lgkmcnt(0)
    v_mfma_f32_16x16x32_bf16 v[48:51], a[96:99], v[112:115], v[48:51]
    v_mfma_f32_16x16x32_bf16 v[60:63], a[100:103], v[112:115], v[60:63]
    v_mfma_f32_16x16x32_bf16 v[72:75], a[104:107], v[112:115], v[72:75]
    v_mfma_f32_16x16x32_bf16 v[84:87], a[108:111], v[112:115], v[84:87]
    v_exp_f32 v104, v104
    v_exp_f32 v105, v105
    v_exp_f32 v106, v106
    v_cvt_pk_bf16_f32 v116, v104, v105
    v_add_f32 v134, v134, v104
    v_exp_f32 v107, v107
    v_exp_f32 v108, v108
    v_cvt_pk_bf16_f32 v117, v106, v107
    v_add_f32 v135, v135, v105
    v_add_f32 v134, v134, v106
    v_add_f32 v135, v135, v107
    v_mfma_f32_16x16x32_bf16 v[96:99], a[48:51], a[32:35], v[128:131]
    v_mfma_f32_16x16x32_bf16 v[96:99], a[52:55], a[36:39], v[96:99]
    v_mfma_f32_16x16x32_bf16 v[96:99], a[56:59], a[40:43], v[96:99]
    v_mfma_f32_16x16x32_bf16 v[96:99], a[60:63], a[44:47], v[96:99]
    v_mfma_f32_16x16x32_bf16 v[100:103], a[64:67], a[32:35], v[128:131]
    v_mfma_f32_16x16x32_bf16 v[100:103], a[68:71], a[36:39], v[100:103]
    v_mfma_f32_16x16x32_bf16 v[100:103], a[72:75], a[40:43], v[100:103]
    v_mfma_f32_16x16x32_bf16 v[100:103], a[76:79], a[44:47], v[100:103]
    v_exp_f32 v109, v109
    v_exp_f32 v110, v110
    v_cvt_pk_bf16_f32 v118, v108, v109
    v_add_f32 v134, v134, v108
    v_exp_f32 v111, v111
    v_add_f32 v135, v135, v109
    v_add_f32 v134, v134, v110
    v_cvt_pk_bf16_f32 v119, v110, v111
    v_add_f32 v135, v135, v111
    ds_read_b128 a[48:51], v138 offset:0
    ds_read_b128 a[52:55], v138 offset:64
    ds_read_b128 a[56:59], v138 offset:128
    ds_read_b128 a[60:63], v138 offset:192
    v_mfma_f32_16x16x32_bf16 v[4:7], a[80:83], v[116:119], v[4:7]
    v_mfma_f32_16x16x32_bf16 v[16:19], a[84:87], v[116:119], v[16:19]
    v_mfma_f32_16x16x32_bf16 v[28:31], a[88:91], v[116:119], v[28:31]
    v_mfma_f32_16x16x32_bf16 v[40:43], a[92:95], v[116:119], v[40:43]
    v_mfma_f32_16x16x32_bf16 v[52:55], a[96:99], v[116:119], v[52:55]
    v_mfma_f32_16x16x32_bf16 v[64:67], a[100:103], v[116:119], v[64:67]
    v_mfma_f32_16x16x32_bf16 v[76:79], a[104:107], v[116:119], v[76:79]
    v_mfma_f32_16x16x32_bf16 v[88:91], a[108:111], v[116:119], v[88:91]
    v_exp_f32 v96, v96
    v_exp_f32 v97, v97
    ds_read_b128 a[64:67], v138 offset:512
    v_exp_f32 v98, v98
    ds_read_b128 a[68:71], v138 offset:576
    v_cvt_pk_bf16_f32 v112, v96, v97
    v_add_f32 v136, v136, v96
    v_exp_f32 v99, v99
    ds_read_b128 a[72:75], v138 offset:640
    v_exp_f32 v100, v100
    v_cvt_pk_bf16_f32 v113, v98, v99
    v_add_f32 v137, v137, v97
    v_add_f32 v136, v136, v98
    v_add_f32 v137, v137, v99
    ds_read_b128 a[76:79], v138 offset:704
    s_waitcnt lgkmcnt(4)
    v_mfma_f32_16x16x32_bf16 v[104:107], a[48:51], a[0:3], v[120:123]
    v_mfma_f32_16x16x32_bf16 v[104:107], a[52:55], a[4:7], v[104:107]
    v_mfma_f32_16x16x32_bf16 v[104:107], a[56:59], a[8:11], v[104:107]
    v_mfma_f32_16x16x32_bf16 v[104:107], a[60:63], a[12:15], v[104:107]
    s_waitcnt lgkmcnt(0)
    v_mfma_f32_16x16x32_bf16 v[108:111], a[64:67], a[0:3], v[120:123]
    v_mfma_f32_16x16x32_bf16 v[108:111], a[68:71], a[4:7], v[108:111]
    v_mfma_f32_16x16x32_bf16 v[108:111], a[72:75], a[8:11], v[108:111]
    v_mfma_f32_16x16x32_bf16 v[108:111], a[76:79], a[12:15], v[108:111]
    v_exp_f32 v101, v101
    v_exp_f32 v102, v102
    v_cvt_pk_bf16_f32 v114, v100, v101
    v_add_f32 v136, v136, v100
    v_exp_f32 v103, v103
    v_add_f32 v137, v137, v101
    v_add_f32 v136, v136, v102
    v_cvt_pk_bf16_f32 v115, v102, v103
    v_add_f32 v137, v137, v103
    s_barrier
    v_mfma_f32_16x16x32_bf16 v[8:11], a[80:83], v[112:115], v[8:11]
    v_mfma_f32_16x16x32_bf16 v[20:23], a[84:87], v[112:115], v[20:23]
    v_mfma_f32_16x16x32_bf16 v[32:35], a[88:91], v[112:115], v[32:35]
    v_mfma_f32_16x16x32_bf16 v[44:47], a[92:95], v[112:115], v[44:47]
    v_mfma_f32_16x16x32_bf16 v[56:59], a[96:99], v[112:115], v[56:59]
    v_mfma_f32_16x16x32_bf16 v[68:71], a[100:103], v[112:115], v[68:71]
    v_mfma_f32_16x16x32_bf16 v[80:83], a[104:107], v[112:115], v[80:83]
    v_mfma_f32_16x16x32_bf16 v[92:95], a[108:111], v[112:115], v[92:95]
    v_exp_f32 v104, v104
    ds_read_b64_tr_b16 a[80:81], v139 offset:16896
    v_exp_f32 v105, v105
    ds_read_b64_tr_b16 a[82:83], v139 offset:17408
    v_exp_f32 v106, v106
    ds_read_b64_tr_b16 a[84:85], v139 offset:16928
    v_cvt_pk_bf16_f32 v116, v104, v105
    v_add_f32 v132, v132, v104
    ds_read_b64_tr_b16 a[86:87], v139 offset:17440
    v_exp_f32 v107, v107
    ds_read_b64_tr_b16 a[88:89], v139 offset:16960
    v_exp_f32 v108, v108
    ds_read_b64_tr_b16 a[90:91], v139 offset:17472
    v_cvt_pk_bf16_f32 v117, v106, v107
    v_add_f32 v133, v133, v105
    ds_read_b64_tr_b16 a[92:93], v139 offset:16992
    v_add_f32 v132, v132, v106
    v_add_f32 v133, v133, v107
    ds_read_b64_tr_b16 a[94:95], v139 offset:17504
L_k3:
    v_mfma_f32_16x16x32_bf16 v[96:99], a[48:51], a[16:19], v[124:127]
    v_mfma_f32_16x16x32_bf16 v[96:99], a[52:55], a[20:23], v[96:99]
    v_mfma_f32_16x16x32_bf16 v[96:99], a[56:59], a[24:27], v[96:99]
    v_mfma_f32_16x16x32_bf16 v[96:99], a[60:63], a[28:31], v[96:99]
    v_mfma_f32_16x16x32_bf16 v[100:103], a[64:67], a[16:19], v[124:127]
    v_mfma_f32_16x16x32_bf16 v[100:103], a[68:71], a[20:23], v[100:103]
    v_mfma_f32_16x16x32_bf16 v[100:103], a[72:75], a[24:27], v[100:103]
    v_mfma_f32_16x16x32_bf16 v[100:103], a[76:79], a[28:31], v[100:103]
    v_exp_f32 v109, v109
    ds_read_b64_tr_b16 a[96:97], v139 offset:17024
    v_exp_f32 v110, v110
    ds_read_b64_tr_b16 a[98:99], v139 offset:17536
    v_cvt_pk_bf16_f32 v118, v108, v109
    v_add_f32 v132, v132, v108
    ds_read_b64_tr_b16 a[100:101], v139 offset:17056
    v_exp_f32 v111, v111
    ds_read_b64_tr_b16 a[102:103], v139 offset:17568
    v_add_f32 v133, v133, v109
    v_add_f32 v132, v132, v110
    ds_read_b64_tr_b16 a[104:105], v139 offset:17088
    v_cvt_pk_bf16_f32 v119, v110, v111
    v_add_f32 v133, v133, v111
    ds_read_b64_tr_b16 a[106:107], v139 offset:17600
    ds_read_b64_tr_b16 a[108:109], v139 offset:17120
    ds_read_b64_tr_b16 a[110:111], v139 offset:17632
    s_waitcnt lgkmcnt(8)
    v_mfma_f32_16x16x32_bf16 v[0:3], a[80:83], v[116:119], v[0:3]
    v_mfma_f32_16x16x32_bf16 v[12:15], a[84:87], v[116:119], v[12:15]
    v_mfma_f32_16x16x32_bf16 v[24:27], a[88:91], v[116:119], v[24:27]
    v_mfma_f32_16x16x32_bf16 v[36:39], a[92:95], v[116:119], v[36:39]
    s_waitcnt lgkmcnt(0)
    v_mfma_f32_16x16x32_bf16 v[48:51], a[96:99], v[116:119], v[48:51]
    v_mfma_f32_16x16x32_bf16 v[60:63], a[100:103], v[116:119], v[60:63]
    v_mfma_f32_16x16x32_bf16 v[72:75], a[104:107], v[116:119], v[72:75]
    v_mfma_f32_16x16x32_bf16 v[84:87], a[108:111], v[116:119], v[84:87]
    s_add_u32 s44, s44, 1
    v_exp_f32 v96, v96
    s_and_b32 s46, s44, 3
    v_exp_f32 v97, v97
    s_cselect_b32 s45, s54, 4294865920
    v_exp_f32 v98, v98
    v_cvt_pk_bf16_f32 v112, v96, v97
    v_add_f32 v134, v134, v96
    s_cmp_lt_u32 s44, 2
    v_exp_f32 v99, v99
    v_exp_f32 v100, v100
    v_cvt_pk_bf16_f32 v113, v98, v99
    v_add_f32 v135, v135, v97
    v_add_f32 v134, v134, v98
    v_add_f32 v135, v135, v99
    s_cbranch_scc1 L_loop0
L_loop1:
    v_mfma_f32_16x16x32_bf16 v[104:107], a[48:51], a[32:35], v[128:131]
    v_mfma_f32_16x16x32_bf16 v[104:107], a[52:55], a[36:39], v[104:107]
    v_exp_f32 v101, v101
    v_exp_f32 v102, v102
    v_mfma_f32_16x16x32_bf16 v[104:107], a[56:59], a[40:43], v[104:107]
    v_mfma_f32_16x16x32_bf16 v[104:107], a[60:63], a[44:47], v[104:107]
    v_cvt_pk_bf16_f32 v114, v100, v101
    v_add_f32 v134, v134, v100
    v_exp_f32 v103, v103
    v_mfma_f32_16x16x32_bf16 v[108:111], a[64:67], a[32:35], v[128:131]
    v_mfma_f32_16x16x32_bf16 v[108:111], a[68:71], a[36:39], v[108:111]
    v_add_f32 v135, v135, v101
    v_add_f32 v134, v134, v102
    v_cvt_pk_bf16_f32 v115, v102, v103
    v_add_f32 v135, v135, v103
    v_mfma_f32_16x16x32_bf16 v[108:111], a[72:75], a[40:43], v[108:111]
    v_mfma_f32_16x16x32_bf16 v[108:111], a[76:79], a[44:47], v[108:111]
    ds_read_b128 a[48:51], v138 offset:16896
    ds_read_b128 a[52:55], v138 offset:16960
    ds_read_b128 a[56:59], v138 offset:17024
    ds_read_b128 a[60:63], v138 offset:17088
    v_mfma_f32_16x16x32_bf16 v[4:7], a[80:83], v[112:115], v[4:7]
    v_mfma_f32_16x16x32_bf16 v[16:19], a[84:87], v[112:115], v[16:19]
    v_exp_f32 v104, v104
    ds_read_b128 a[64:67], v138 offset:17408
    v_exp_f32 v105, v105
    v_mfma_f32_16x16x32_bf16 v[28:31], a[88:91], v[112:115], v[28:31]
    v_mfma_f32_16x16x32_bf16 v[40:43], a[92:95], v[112:115], v[40:43]
    ds_read_b128 a[68:71], v138 offset:17472
    v_exp_f32 v106, v106
    v_cvt_pk_bf16_f32 v116, v104, v105
    v_add_f32 v136, v136, v104
    v_mfma_f32_16x16x32_bf16 v[52:55], a[96:99], v[112:115], v[52:55]
    v_mfma_f32_16x16x32_bf16 v[64:67], a[100:103], v[112:115], v[64:67]
    ds_read_b128 a[72:75], v138 offset:17536
    v_exp_f32 v107, v107
    v_exp_f32 v108, v108
    v_mfma_f32_16x16x32_bf16 v[76:79], a[104:107], v[112:115], v[76:79]
    v_mfma_f32_16x16x32_bf16 v[88:91], a[108:111], v[112:115], v[88:91]
    v_cvt_pk_bf16_f32 v117, v106, v107
    v_add_f32 v137, v137, v105
    ds_read_b128 a[76:79], v138 offset:17600
    v_add_f32 v136, v136, v106
    v_add_f32 v137, v137, v107
    s_waitcnt lgkmcnt(4)
    v_mfma_f32_16x16x32_bf16 v[96:99], a[48:51], a[0:3], v[120:123]
    v_mfma_f32_16x16x32_bf16 v[96:99], a[52:55], a[4:7], v[96:99]
    v_exp_f32 v109, v109
    v_exp_f32 v110, v110
    v_mfma_f32_16x16x32_bf16 v[96:99], a[56:59], a[8:11], v[96:99]
    v_mfma_f32_16x16x32_bf16 v[96:99], a[60:63], a[12:15], v[96:99]
    v_cvt_pk_bf16_f32 v118, v108, v109
    v_add_f32 v136, v136, v108
    v_exp_f32 v111, v111
    s_waitcnt lgkmcnt(0)
    v_mfma_f32_16x16x32_bf16 v[100:103], a[64:67], a[0:3], v[120:123]
    v_mfma_f32_16x16x32_bf16 v[100:103], a[68:71], a[4:7], v[100:103]
    v_add_f32 v137, v137, v109
    v_add_f32 v136, v136, v110
    v_cvt_pk_bf16_f32 v119, v110, v111
    v_add_f32 v137, v137, v111
    v_mfma_f32_16x16x32_bf16 v[100:103], a[72:75], a[8:11], v[100:103]
    v_mfma_f32_16x16x32_bf16 v[100:103], a[76:79], a[12:15], v[100:103]
    v_add_u32 v139, s45, v139
    v_add_u32 v138, s45, v138
    s_barrier
    v_mfma_f32_16x16x32_bf16 v[8:11], a[80:83], v[116:119], v[8:11]
    v_mfma_f32_16x16x32_bf16 v[20:23], a[84:87], v[116:119], v[20:23]
    ds_read_b64_tr_b16 a[80:81], v139 offset:0
    v_exp_f32 v96, v96
    ds_read_b64_tr_b16 a[82:83], v139 offset:512
    v_exp_f32 v97, v97
    v_mfma_f32_16x16x32_bf16 v[32:35], a[88:91], v[116:119], v[32:35]
    v_mfma_f32_16x16x32_bf16 v[44:47], a[92:95], v[116:119], v[44:47]
    ds_read_b64_tr_b16 a[84:85], v139 offset:32
    v_exp_f32 v98, v98
    ds_read_b64_tr_b16 a[86:87], v139 offset:544
    v_cvt_pk_bf16_f32 v112, v96, v97
    v_add_f32 v132, v132, v96
    v_mfma_f32_16x16x32_bf16 v[56:59], a[96:99], v[116:119], v[56:59]
    v_mfma_f32_16x16x32_bf16 v[68:71], a[100:103], v[116:119], v[68:71]
    ds_read_b64_tr_b16 a[88:89], v139 offset:64
    v_exp_f32 v99, v99
    ds_read_b64_tr_b16 a[90:91], v139 offset:576
    v_exp_f32 v100, v100
    v_mfma_f32_16x16x32_bf16 v[80:83], a[104:107], v[116:119], v[80:83]
    v_mfma_f32_16x16x32_bf16 v[92:95], a[108:111], v[116:119], v[92:95]
    ds_read_b64_tr_b16 a[92:93], v139 offset:96
    v_cvt_pk_bf16_f32 v113, v98, v99
    v_add_f32 v133, v133, v97
    ds_read_b64_tr_b16 a[94:95], v139 offset:608
    v_add_f32 v132, v132, v98
    v_add_f32 v133, v133, v99
L_k0_1:
    v_mfma_f32_16x16x32_bf16 v[104:107], a[48:51], a[16:19], v[124:127]
    v_mfma_f32_16x16x32_bf16 v[104:107], a[52:55], a[20:23], v[104:107]
    ds_read_b64_tr_b16 a[96:97], v139 offset:128
    v_exp_f32 v101, v101
    ds_read_b64_tr_b16 a[98:99], v139 offset:640
    v_exp_f32 v102, v102
    v_mfma_f32_16x16x32_bf16 v[104:107], a[56:59], a[24:27], v[104:107]
    v_mfma_f32_16x16x32_bf16 v[104:107], a[60:63], a[28:31], v[104:107]
    ds_read_b64_tr_b16 a[100:101], v139 offset:160
    v_cvt_pk_bf16_f32 v114, v100, v101
    v_add_f32 v132, v132, v100
    ds_read_b64_tr_b16 a[102:103], v139 offset:672
    v_exp_f32 v103, v103
    v_mfma_f32_16x16x32_bf16 v[108:111], a[64:67], a[16:19], v[124:127]
    v_mfma_f32_16x16x32_bf16 v[108:111], a[68:71], a[20:23], v[108:111]
    ds_read_b64_tr_b16 a[104:105], v139 offset:192
    v_add_f32 v133, v133, v101
    v_add_f32 v132, v132, v102
    ds_read_b64_tr_b16 a[106:107], v139 offset:704
    v_cvt_pk_bf16_f32 v115, v102, v103
    v_add_f32 v133, v133, v103
    v_mfma_f32_16x16x32_bf16 v[108:111], a[72:75], a[24:27], v[108:111]
    v_mfma_f32_16x16x32_bf16 v[108:111], a[76:79], a[28:31], v[108:111]
    ds_read_b64_tr_b16 a[108:109], v139 offset:224
    ds_read_b64_tr_b16 a[110:111], v139 offset:736
    s_waitcnt lgkmcnt(8)
    v_mfma_f32_16x16x32_bf16 v[0:3], a[80:83], v[112:115], v[0:3]
    v_mfma_f32_16x16x32_bf16 v[12:15], a[84:87], v[112:115], v[12:15]
    v_exp_f32 v104, v104
    v_exp_f32 v105, v105
    v_mfma_f32_16x16x32_bf16 v[24:27], a[88:91], v[112:115], v[24:27]
    v_mfma_f32_16x16x32_bf16 v[36:39], a[92:95], v[112:115], v[36:39]
    v_exp_f32 v106, v106
    v_cvt_pk_bf16_f32 v116, v104, v105
    v_add_f32 v134, v134, v104
    s_waitcnt lgkmcnt(0)
    v_mfma_f32_16x16x32_bf16 v[48:51], a[96:99], v[112:115], v[48:51]
    v_mfma_f32_16x16x32_bf16 v[60:63], a[100:103], v[112:115], v[60:63]
    v_exp_f32 v107, v107
    v_exp_f32 v108, v108
    v_mfma_f32_16x16x32_bf16 v[72:75], a[104:107], v[112:115], v[72:75]
    v_mfma_f32_16x16x32_bf16 v[84:87], a[108:111], v[112:115], v[84:87]
    v_cvt_pk_bf16_f32 v117, v106, v107
    v_add_f32 v135, v135, v105
    v_add_f32 v134, v134, v106
    v_add_f32 v135, v135, v107
    v_mfma_f32_16x16x32_bf16 v[96:99], a[48:51], a[32:35], v[128:131]
    v_mfma_f32_16x16x32_bf16 v[96:99], a[52:55], a[36:39], v[96:99]
    v_exp_f32 v109, v109
    v_exp_f32 v110, v110
    v_mfma_f32_16x16x32_bf16 v[96:99], a[56:59], a[40:43], v[96:99]
    v_mfma_f32_16x16x32_bf16 v[96:99], a[60:63], a[44:47], v[96:99]
    v_cvt_pk_bf16_f32 v118, v108, v109
    v_add_f32 v134, v134, v108
    v_exp_f32 v111, v111
    v_mfma_f32_16x16x32_bf16 v[100:103], a[64:67], a[32:35], v[128:131]
    v_mfma_f32_16x16x32_bf16 v[100:103], a[68:71], a[36:39], v[100:103]
    v_add_f32 v135, v135, v109
    v_add_f32 v134, v134, v110
    v_cvt_pk_bf16_f32 v119, v110, v111
    v_add_f32 v135, v135, v111
    v_mfma_f32_16x16x32_bf16 v[100:103], a[72:75], a[40:43], v[100:103]
    v_mfma_f32_16x16x32_bf16 v[100:103], a[76:79], a[44:47], v[100:103]
    ds_read_b128 a[48:51], v138 offset:0
    ds_read_b128 a[52:55], v138 offset:64
    ds_read_b128 a[56:59], v138 offset:128
    ds_read_b128 a[60:63], v138 offset:192
    v_mfma_f32_16x16x32_bf16 v[4:7], a[80:83], v[116:119], v[4:7]
    v_mfma_f32_16x16x32_bf16 v[16:19], a[84:87], v[116:119], v[16:19]
    v_exp_f32 v96, v96
    ds_read_b128 a[64:67], v138 offset:512
    v_exp_f32 v97, v97
    v_mfma_f32_16x16x32_bf16 v[28:31], a[88:91], v[116:119], v[28:31]
    v_mfma_f32_16x16x32_bf16 v[40:43], a[92:95], v[116:119], v[40:43]
    ds_read_b128 a[68:71], v138 offset:576
    v_exp_f32 v98, v98
    v_cvt_pk_bf16_f32 v112, v96, v97
    v_add_f32 v136, v136, v96
    v_mfma_f32_16x16x32_bf16 v[52:55], a[96:99], v[116:119], v[52:55]
    v_mfma_f32_16x16x32_bf16 v[64:67], a[100:103], v[116:119], v[64:67]
    ds_read_b128 a[72:75], v138 offset:640
    v_exp_f32 v99, v99
    v_exp_f32 v100, v100
    v_mfma_f32_16x16x32_bf16 v[76:79], a[104:107], v[116:119], v[76:79]
    v_mfma_f32_16x16x32_bf16 v[88:91], a[108:111], v[116:119], v[88:91]
    v_cvt_pk_bf16_f32 v113, v98, v99
    v_add_f32 v137, v137, v97
    ds_read_b128 a[76:79], v138 offset:704
    v_add_f32 v136, v136, v98
    v_add_f32 v137, v137, v99
    s_waitcnt lgkmcnt(4)
    v_mfma_f32_16x16x32_bf16 v[104:107], a[48:51], a[0:3], v[120:123]
    v_mfma_f32_16x16x32_bf16 v[104:107], a[52:55], a[4:7], v[104:107]
    v_exp_f32 v101, v101
    v_exp_f32 v102, v102
    v_mfma_f32_16x16x32_bf16 v[104:107], a[56:59], a[8:11], v[104:107]
    v_mfma_f32_16x16x32_bf16 v[104:107], a[60:63], a[12:15], v[104:107]
    v_cvt_pk_bf16_f32 v114, v100, v101
    v_add_f32 v136, v136, v100
    v_exp_f32 v103, v103
    s_waitcnt lgkmcnt(0)
    v_mfma_f32_16x16x32_bf16 v[108:111], a[64:67], a[0:3], v[120:123]
    v_mfma_f32_16x16x32_bf16 v[108:111], a[68:71], a[4:7], v[108:111]
    v_add_f32 v137, v137, v101
    v_add_f32 v136, v136, v102
    v_cvt_pk_bf16_f32 v115, v102, v103
    v_add_f32 v137, v137, v103
    v_mfma_f32_16x16x32_bf16 v[108:111], a[72:75], a[8:11], v[108:111]
    v_mfma_f32_16x16x32_bf16 v[108:111], a[76:79], a[12:15], v[108:111]
    s_barrier
    v_mfma_f32_16x16x32_bf16 v[8:11], a[80:83], v[112:115], v[8:11]
    v_mfma_f32_16x16x32_bf16 v[20:23], a[84:87], v[112:115], v[20:23]
    ds_read_b64_tr_b16 a[80:81], v139 offset:16896
    v_exp_f32 v104, v104
    ds_read_b64_tr_b16 a[82:83], v139 offset:17408
    v_exp_f32 v105, v105
    v_mfma_f32_16x16x32_bf16 v[32:35], a[88:91], v[112:115], v[32:35]
    v_mfma_f32_16x16x32_bf16 v[44:47], a[92:95], v[112:115], v[44:47]
    ds_read_b64_tr_b16 a[84:85], v139 offset:16928
    v_exp_f32 v106, v106
    ds_read_b64_tr_b16 a[86:87], v139 offset:17440
    v_cvt_pk_bf16_f32 v116, v104, v105
    v_add_f32 v132, v132, v104
    v_mfma_f32_16x16x32_bf16 v[56:59], a[96:99], v[112:115], v[56:59]
    v_mfma_f32_16x16x32_bf16 v[68:71], a[100:103], v[112:115], v[68:71]
    ds_read_b64_tr_b16 a[88:89], v139 offset:16960
    v_exp_f32 v107, v107
    ds_read_b64_tr_b16 a[90:91], v139 offset:17472
    v_exp_f32 v108, v108
    v_mfma_f32_16x16x32_bf16 v[80:83], a[104:107], v[112:115], v[80:83]
    v_mfma_f32_16x16x32_bf16 v[92:95], a[108:111], v[112:115], v[92:95]
    ds_read_b64_tr_b16 a[92:93], v139 offset:16992
    v_cvt_pk_bf16_f32 v117, v106, v107
    v_add_f32 v133, v133, v105
    ds_read_b64_tr_b16 a[94:95], v139 offset:17504
    v_add_f32 v132, v132, v106
    v_add_f32 v133, v133, v107
    v_mfma_f32_16x16x32_bf16 v[96:99], a[48:51], a[16:19], v[124:127]
    v_mfma_f32_16x16x32_bf16 v[96:99], a[52:55], a[20:23], v[96:99]
    ds_read_b64_tr_b16 a[96:97], v139 offset:17024
    v_exp_f32 v109, v109
    ds_read_b64_tr_b16 a[98:99], v139 offset:17536
    v_exp_f32 v110, v110
    v_mfma_f32_16x16x32_bf16 v[96:99], a[56:59], a[24:27], v[96:99]
    v_mfma_f32_16x16x32_bf16 v[96:99], a[60:63], a[28:31], v[96:99]
    ds_read_b64_tr_b16 a[100:101], v139 offset:17056
    v_cvt_pk_bf16_f32 v118, v108, v109
    v_add_f32 v132, v132, v108
    ds_read_b64_tr_b16 a[102:103], v139 offset:17568
    v_exp_f32 v111, v111
    v_mfma_f32_16x16x32_bf16 v[100:103], a[64:67], a[16:19], v[124:127]
    v_mfma_f32_16x16x32_bf16 v[100:103], a[68:71], a[20:23], v[100:103]
    ds_read_b64_tr_b16 a[104:105], v139 offset:17088
    v_add_f32 v133, v133, v109
    v_add_f32 v132, v132, v110
    ds_read_b64_tr_b16 a[106:107], v139 offset:17600
    v_cvt_pk_bf16_f32 v119, v110, v111
    v_add_f32 v133, v133, v111
    v_mfma_f32_16x16x32_bf16 v[100:103], a[72:75], a[24:27], v[100:103]
    v_mfma_f32_16x16x32_bf16 v[100:103], a[76:79], a[28:31], v[100:103]
    ds_read_b64_tr_b16 a[108:109], v139 offset:17120
    ds_read_b64_tr_b16 a[110:111], v139 offset:17632
    s_waitcnt lgkmcnt(8)
    v_mfma_f32_16x16x32_bf16 v[0:3], a[80:83], v[116:119], v[0:3]
    v_mfma_f32_16x16x32_bf16 v[12:15], a[84:87], v[116:119], v[12:15]
    s_add_u32 s44, s44, 1
    v_exp_f32 v96, v96
    s_and_b32 s46, s44, 3
    v_exp_f32 v97, v97
    v_mfma_f32_16x16x32_bf16 v[24:27], a[88:91], v[116:119], v[24:27]
    v_mfma_f32_16x16x32_bf16 v[36:39], a[92:95], v[116:119], v[36:39]
    s_cselect_b32 s45, s54, 4294865920
    v_exp_f32 v98, v98
    v_cvt_pk_bf16_f32 v112, v96, v97
    v_add_f32 v134, v134, v96
    s_waitcnt lgkmcnt(0)
    v_mfma_f32_16x16x32_bf16 v[48:51], a[96:99], v[116:119], v[48:51]
    v_mfma_f32_16x16x32_bf16 v[60:63], a[100:103], v[116:119], v[60:63]
    s_cmp_lt_u32 s44, 3
    v_exp_f32 v99, v99
    v_exp_f32 v100, v100
    v_mfma_f32_16x16x32_bf16 v[72:75], a[104:107], v[116:119], v[72:75]
    v_mfma_f32_16x16x32_bf16 v[84:87], a[108:111], v[116:119], v[84:87]
    v_cvt_pk_bf16_f32 v113, v98, v99
    v_add_f32 v135, v135, v97
    v_add_f32 v134, v134, v98
    v_add_f32 v135, v135, v99
    s_cbranch_scc1 L_loop1
L_loop2:
    v_mfma_f32_16x16x32_bf16 v[104:107], a[48:51], a[32:35], v[128:131]
    v_exp_f32 v101, v101
    v_mfma_f32_16x16x32_bf16 v[104:107], a[52:55], a[36:39], v[104:107]
    v_exp_f32 v102, v102
    v_mfma_f32_16x16x32_bf16 v[104:107], a[56:59], a[40:43], v[104:107]
    v_cvt_pk_bf16_f32 v114, v100, v101
    v_add_f32 v134, v134, v100
    v_mfma_f32_16x16x32_bf16 v[104:107], a[60:63], a[44:47], v[104:107]
    v_exp_f32 v103, v103
    v_mfma_f32_16x16x32_bf16 v[108:111], a[64:67], a[32:35], v[128:131]
    v_add_f32 v135, v135, v101
    v_add_f32 v134, v134, v102
    v_mfma_f32_16x16x32_bf16 v[108:111], a[68:71], a[36:39], v[108:111]
    v_cvt_pk_bf16_f32 v115, v102, v103
    v_add_f32 v135, v135, v103
    v_mfma_f32_16x16x32_bf16 v[108:111], a[72:75], a[40:43], v[108:111]
    ds_read_b128 a[48:51], v138 offset:16896
    ds_read_b128 a[52:55], v138 offset:16960
    v_mfma_f32_16x16x32_bf16 v[108:111], a[76:79], a[44:47], v[108:111]
    ds_read_b128 a[56:59], v138 offset:17024
    ds_read_b128 a[60:63], v138 offset:17088
    v_mfma_f32_16x16x32_bf16 v[4:7], a[80:83], v[112:115], v[4:7]
    v_exp_f32 v104, v104
    v_mfma_f32_16x16x32_bf16 v[16:19], a[84:87], v[112:115], v[16:19]
    v_exp_f32 v105, v105
    ds_read_b128 a[64:67], v138 offset:17408
    v_mfma_f32_16x16x32_bf16 v[28:31], a[88:91], v[112:115], v[28:31]
    v_exp_f32 v106, v106
    ds_read_b128 a[68:71], v138 offset:17472
    v_mfma_f32_16x16x32_bf16 v[40:43], a[92:95], v[112:115], v[40:43]
    v_cvt_pk_bf16_f32 v116, v104, v105
    v_add_f32 v136, v136, v104
    v_mfma_f32_16x16x32_bf16 v[52:55], a[96:99], v[112:115], v[52:55]
    v_exp_f32 v107, v107
    ds_read_b128 a[72:75], v138 offset:17536
    v_mfma_f32_16x16x32_bf16 v[64:67], a[100:103], v[112:115], v[64:67]
    v_exp_f32 v108, v108
    v_mfma_f32_16x16x32_bf16 v[76:79], a[104:107], v[112:115], v[76:79]
    v_cvt_pk_bf16_f32 v117, v106, v107
    v_add_f32 v137, v137, v105
    v_mfma_f32_16x16x32_bf16 v[88:91], a[108:111], v[112:115], v[88:91]
    v_add_f32 v136, v136, v106
    v_add_f32 v137, v137, v107
    ds_read_b128 a[76:79], v138 offset:17600
    s_waitcnt lgkmcnt(4)
    v_mfma_f32_16x16x32_bf16 v[96:99], a[48:51], a[0:3], v[120:123]
    v_exp_f32 v109, v109
    v_mfma_f32_16x16x32_bf16 v[96:99], a[52:55], a[4:7], v[96:99]
    v_exp_f32 v110, v110
    v_mfma_f32_16x16x32_bf16 v[96:99], a[56:59], a[8:11], v[96:99]
    v_cvt_pk_bf16_f32 v118, v108, v109
    v_add_f32 v136, v136, v108
    v_mfma_f32_16x16x32_bf16 v[96:99], a[60:63], a[12:15], v[96:99]
    v_exp_f32 v111, v111
    s_waitcnt lgkmcnt(0)
    v_mfma_f32_16x16x32_bf16 v[100:103], a[64:67], a[0:3], v[120:123]
    v_add_f32 v137, v137, v109
    v_add_f32 v136, v136, v110
    v_mfma_f32_16x16x32_bf16 v[100:103], a[68:71], a[4:7], v[100:103]
    v_cvt_pk_bf16_f32 v119, v110, v111
    v_add_f32 v137, v137, v111
    v_mfma_f32_16x16x32_bf16 v[100:103], a[72:75], a[8:11], v[100:103]
    v_add_u32 v139, s45, v139
    v_mfma_f32_16x16x32_bf16 v[100:103], a[76:79], a[12:15], v[100:103]
    v_add_u32 v138, s45, v138
    s_barrier
    v_mfma_f32_16x16x32_bf16 v[8:11], a[80:83], v[116:119], v[8:11]
    v_exp_f32 v96, v96
    ds_read_b64_tr_b16 a[80:81], v139 offset:0
    v_mfma_f32_16x16x32_bf16 v[20:23], a[84:87], v[116:119], v[20:23]
    v_exp_f32 v97, v97
    ds_read_b64_tr_b16 a[82:83], v139 offset:512
    v_mfma_f32_16x16x32_bf16 v[32:35], a[88:91], v[116:119], v[32:35]
    v_exp_f32 v98, v98
    ds_read_b64_tr_b16 a[84:85], v139 offset:32
    v_mfma_f32_16x16x32_bf16 v[44:47], a[92:95], v[116:119], v[44:47]
    v_cvt_pk_bf16_f32 v112, v96, v97
    v_add_f32 v132, v132, v96
    ds_read_b64_tr_b16 a[86:87], v139 offset:544
    v_mfma_f32_16x16x32_bf16 v[56:59], a[96:99], v[116:119], v[56:59]
    v_exp_f32 v99, v99
    ds_read_b64_tr_b16 a[88:89], v139 offset:64
    v_mfma_f32_16x16x32_bf16 v[68:71], a[100:103], v[116:119], v[68:71]
    v_exp_f32 v100, v100
    ds_read_b64_tr_b16 a[90:91], v139 offset:576
    v_mfma_f32_16x16x32_bf16 v[80:83], a[104:107], v[116:119], v[80:83]
    v_cvt_pk_bf16_f32 v113, v98, v99
    v_add_f32 v133, v133, v97
    ds_read_b64_tr_b16 a[92:93], v139 offset:96
    v_mfma_f32_16x16x32_bf16 v[92:95], a[108:111], v[116:119], v[92:95]
    v_add_f32 v132, v132, v98
    v_add_f32 v133, v133, v99
    ds_read_b64_tr_b16 a[94:95], v139 offset:608
L_k0_2:
    v_mfma_f32_16x16x32_bf16 v[104:107], a[48:51], a[16:19], v[124:127]
    v_exp_f32 v101, v101
    ds_read_b64_tr_b16 a[96:97], v139 offset:128
    v_mfma_f32_16x16x32_bf16 v[104:107], a[52:55], a[20:23], v[104:107]
    v_exp_f32 v102, v102
    ds_read_b64_tr_b16 a[98:99], v139 offset:640
    v_mfma_f32_16x16x32_bf16 v[104:107], a[56:59], a[24:27], v[104:107]
    v_cvt_pk_bf16_f32 v114, v100, v101
    v_add_f32 v132, v132, v100
    ds_read_b64_tr_b16 a[100:101], v139 offset:160
    v_mfma_f32_16x16x32_bf16 v[104:107], a[60:63], a[28:31], v[104:107]
    v_exp_f32 v103, v103
    ds_read_b64_tr_b16 a[102:103], v139 offset:672
    v_mfma_f32_16x16x32_bf16 v[108:111], a[64:67], a[16:19], v[124:127]
    v_add_f32 v133, v133, v101
    v_add_f32 v132, v132, v102
    ds_read_b64_tr_b16 a[104:105], v139 offset:192
    v_mfma_f32_16x16x32_bf16 v[108:111], a[68:71], a[20:23], v[108:111]
    v_cvt_pk_bf16_f32 v115, v102, v103
    v_add_f32 v133, v133, v103
    ds_read_b64_tr_b16 a[106:107], v139 offset:704
    v_mfma_f32_16x16x32_bf16 v[108:111], a[72:75], a[24:27], v[108:111]
    ds_read_b64_tr_b16 a[108:109], v139 offset:224
    v_mfma_f32_16x16x32_bf16 v[108:111], a[76:79], a[28:31], v[108:111]
    ds_read_b64_tr_b16 a[110:111], v139 offset:736
    s_waitcnt lgkmcnt(8)
    v_mfma_f32_16x16x32_bf16 v[0:3], a[80:83], v[112:115], v[0:3]
    v_exp_f32 v104, v104
    v_mfma_f32_16x16x32_bf16 v[12:15], a[84:87], v[112:115], v[12:15]
    v_exp_f32 v105, v105
    v_mfma_f32_16x16x32_bf16 v[24:27], a[88:91], v[112:115], v[24:27]
    v_exp_f32 v106, v106
    v_mfma_f32_16x16x32_bf16 v[36:39], a[92:95], v[112:115], v[36:39]
    v_cvt_pk_bf16_f32 v116, v104, v105
    v_add_f32 v134, v134, v104
    s_waitcnt lgkmcnt(0)
    v_mfma_f32_16x16x32_bf16 v[48:51], a[96:99], v[112:115], v[48:51]
    v_exp_f32 v107, v107
    v_mfma_f32_16x16x32_bf16 v[60:63], a[100:103], v[112:115], v[60:63]
    v_exp_f32 v108, v108
    v_mfma_f32_16x16x32_bf16 v[72:75], a[104:107], v[112:115], v[72:75]
    v_cvt_pk_bf16_f32 v117, v106, v107
    v_add_f32 v135, v135, v105
    v_mfma_f32_16x16x32_bf16 v[84:87], a[108:111], v[112:115], v[84:87]
    v_add_f32 v134, v134, v106
    v_add_f32 v135, v135, v107
    v_mfma_f32_16x16x32_bf16 v[96:99], a[48:51], a[32:35], v[128:131]
    v_exp_f32 v109, v109
    v_mfma_f32_16x16x32_bf16 v[96:99], a[52:55], a[36:39], v[96:99]
    v_exp_f32 v110, v110
    v_mfma_f32_16x16x32_bf16 v[96:99], a[56:59], a[40:43], v[96:99]
    v_cvt_pk_bf16_f32 v118, v108, v109
    v_add_f32 v134, v134, v108
    v_mfma_f32_16x16x32_bf16 v[96:99], a[60:63], a[44:47], v[96:99]
    v_exp_f32 v111, v111
    v_mfma_f32_16x16x32_bf16 v[100:103], a[64:67], a[32:35], v[128:131]
    v_add_f32 v135, v135, v109
    v_add_f32 v134, v134, v110
    v_mfma_f32_16x16x32_bf16 v[100:103], a[68:71], a[36:39], v[100:103]
    v_cvt_pk_bf16_f32 v119, v110, v111
    v_add_f32 v135, v135, v111
    v_mfma_f32_16x16x32_bf16 v[100:103], a[72:75], a[40:43], v[100:103]
    ds_read_b128 a[48:51], v138 offset:0
    ds_read_b128 a[52:55], v138 offset:64
    v_mfma_f32_16x16x32_bf16 v[100:103], a[76:79], a[44:47], v[100:103]
    ds_read_b128 a[56:59], v138 offset:128
    ds_read_b128 a[60:63], v138 offset:192
    v_mfma_f32_16x16x32_bf16 v[4:7], a[80:83], v[116:119], v[4:7]
    v_exp_f32 v96, v96
    v_mfma_f32_16x16x32_bf16 v[16:19], a[84:87], v[116:119], v[16:19]
    v_exp_f32 v97, v97
    ds_read_b128 a[64:67], v138 offset:512
    v_mfma_f32_16x16x32_bf16 v[28:31], a[88:91], v[116:119], v[28:31]
    v_exp_f32 v98, v98
    ds_read_b128 a[68:71], v138 offset:576
    v_mfma_f32_16x16x32_bf16 v[40:43], a[92:95], v[116:119], v[40:43]
    v_cvt_pk_bf16_f32 v112, v96, v97
    v_add_f32 v136, v136, v96
    v_mfma_f32_16x16x32_bf16 v[52:55], a[96:99], v[116:119], v[52:55]
    v_exp_f32 v99, v99
    ds_read_b128 a[72:75], v138 offset:640
    v_mfma_f32_16x16x32_bf16 v[64:67], a[100:103], v[116:119], v[64:67]
    v_exp_f32 v100, v100
    v_mfma_f32_16x16x32_bf16 v[76:79], a[104:107], v[116:119], v[76:79]
    v_cvt_pk_bf16_f32 v113, v98, v99
    v_add_f32 v137, v137, v97
    v_mfma_f32_16x16x32_bf16 v[88:91], a[108:111], v[116:119], v[88:91]
    v_add_f32 v136, v136, v98
    v_add_f32 v137, v137, v99
    ds_read_b128 a[76:79], v138 offset:704
    s_waitcnt lgkmcnt(4)
    v_mfma_f32_16x16x32_bf16 v[104:107], a[48:51], a[0:3], v[120:123]
    v_exp_f32 v101, v101
    v_mfma_f32_16x16x32_bf16 v[104:107], a[52:55], a[4:7], v[104:107]
    v_exp_f32 v102, v102
    v_mfma_f32_16x16x32_bf16 v[104:107], a[56:59], a[8:11], v[104:107]
    v_cvt_pk_bf16_f32 v114, v100, v101
    v_add_f32 v136, v136, v100
    v_mfma_f32_16x16x32_bf16 v[104:107], a[60:63], a[12:15], v[104:107]
    v_exp_f32 v103, v103
    s_waitcnt lgkmcnt(0)
    v_mfma_f32_16x16x32_bf16 v[108:111], a[64:67], a[0:3], v[120:123]
    v_add_f32 v137, v137, v101
    v_add_f32 v136, v136, v102
    v_mfma_f32_16x16x32_bf16 v[108:111], a[68:71], a[4:7], v[108:111]
    v_cvt_pk_bf16_f32 v115, v102, v103
    v_add_f32 v137, v137, v103
    v_mfma_f32_16x16x32_bf16 v[108:111], a[72:75], a[8:11], v[108:111]
    v_mfma_f32_16x16x32_bf16 v[108:111], a[76:79], a[12:15], v[108:111]
    s_barrier
    v_mfma_f32_16x16x32_bf16 v[8:11], a[80:83], v[112:115], v[8:11]
    v_exp_f32 v104, v104
    ds_read_b64_tr_b16 a[80:81], v139 offset:16896
    v_mfma_f32_16x16x32_bf16 v[20:23], a[84:87], v[112:115], v[20:23]
    v_exp_f32 v105, v105
    ds_read_b64_tr_b16 a[82:83], v139 offset:17408
    v_mfma_f32_16x16x32_bf16 v[32:35], a[88:91], v[112:115], v[32:35]
    v_exp_f32 v106, v106
    ds_read_b64_tr_b16 a[84:85], v139 offset:16928
    v_mfma_f32_16x16x32_bf16 v[44:47], a[92:95], v[112:115], v[44:47]
    v_cvt_pk_bf16_f32 v116, v104, v105
    v_add_f32 v132, v132, v104
    ds_read_b64_tr_b16 a[86:87], v139 offset:17440
    v_mfma_f32_16x16x32_bf16 v[56:59], a[96:99], v[112:115], v[56:59]
    v_exp_f32 v107, v107
    ds_read_b64_tr_b16 a[88:89], v139 offset:16960
    v_mfma_f32_16x16x32_bf16 v[68:71], a[100:103], v[112:115], v[68:71]
    v_exp_f32 v108, v108
    ds_read_b64_tr_b16 a[90:91], v139 offset:17472
    v_mfma_f32_16x16x32_bf16 v[80:83], a[104:107], v[112:115], v[80:83]
    v_cvt_pk_bf16_f32 v117, v106, v107
    v_add_f32 v133, v133, v105
    ds_read_b64_tr_b16 a[92:93], v139 offset:16992
    v_mfma_f32_16x16x32_bf16 v[92:95], a[108:111], v[112:115], v[92:95]
    v_add_f32 v132, v132, v106
    v_add_f32 v133, v133, v107
    ds_read_b64_tr_b16 a[94:95], v139 offset:17504
    v_mfma_f32_16x16x32_bf16 v[96:99], a[48:51], a[16:19], v[124:127]
    v_exp_f32 v109, v109
    ds_read_b64_tr_b16 a[96:97], v139 offset:17024
    v_mfma_f32_16x16x32_bf16 v[96:99], a[52:55], a[20:23], v[96:99]
    v_exp_f32 v110, v110
    ds_read_b64_tr_b16 a[98:99], v139 offset:17536
    v_mfma_f32_16x16x32_bf16 v[96:99], a[56:59], a[24:27], v[96:99]
    v_cvt_pk_bf16_f32 v118, v108, v109
    v_add_f32 v132, v132, v108
    ds_read_b64_tr_b16 a[100:101], v139 offset:17056
    v_mfma_f32_16x16x32_bf16 v[96:99], a[60:63], a[28:31], v[96:99]
    v_exp_f32 v111, v111
    ds_read_b64_tr_b16 a[102:103], v139 offset:17568
    v_mfma_f32_16x16x32_bf16 v[100:103], a[64:67], a[16:19], v[124:127]
    v_add_f32 v133, v133, v109
    v_add_f32 v132, v132, v110
    ds_read_b64_tr_b16 a[104:105], v139 offset:17088
    v_mfma_f32_16x16x32_bf16 v[100:103], a[68:71], a[20:23], v[100:103]
    v_cvt_pk_bf16_f32 v119, v110, v111
    v_add_f32 v133, v133, v111
    ds_read_b64_tr_b16 a[106:107], v139 offset:17600
    v_mfma_f32_16x16x32_bf16 v[100:103], a[72:75], a[24:27], v[100:103]
    ds_read_b64_tr_b16 a[108:109], v139 offset:17120
    v_mfma_f32_16x16x32_bf16 v[100:103], a[76:79], a[28:31], v[100:103]
    ds_read_b64_tr_b16 a[110:111], v139 offset:17632
    s_waitcnt lgkmcnt(8)
    v_mfma_f32_16x16x32_bf16 v[0:3], a[80:83], v[116:119], v[0:3]
    s_add_u32 s44, s44, 1
    v_exp_f32 v96, v96
    v_mfma_f32_16x16x32_bf16 v[12:15], a[84:87], v[116:119], v[12:15]
    s_and_b32 s46, s44, 3
    v_exp_f32 v97, v97
    v_mfma_f32_16x16x32_bf16 v[24:27], a[88:91], v[116:119], v[24:27]
    s_cselect_b32 s45, s54, 4294865920
    v_exp_f32 v98, v98
    v_mfma_f32_16x16x32_bf16 v[36:39], a[92:95], v[116:119], v[36:39]
    v_cvt_pk_bf16_f32 v112, v96, v97
    v_add_f32 v134, v134, v96
    s_waitcnt lgkmcnt(0)
    v_mfma_f32_16x16x32_bf16 v[48:51], a[96:99], v[116:119], v[48:51]
    s_cmp_lt_u32 s44, 5
    v_exp_f32 v99, v99
    v_mfma_f32_16x16x32_bf16 v[60:63], a[100:103], v[116:119], v[60:63]
    v_exp_f32 v100, v100
    v_mfma_f32_16x16x32_bf16 v[72:75], a[104:107], v[116:119], v[72:75]
    v_cvt_pk_bf16_f32 v113, v98, v99
    v_add_f32 v135, v135, v97
    v_mfma_f32_16x16x32_bf16 v[84:87], a[108:111], v[116:119], v[84:87]
    v_add_f32 v134, v134, v98
    v_add_f32 v135, v135, v99
    s_cbranch_scc1 L_loop2
L_loop3:
    v_mfma_f32_16x16x32_bf16 v[104:107], a[48:51], a[32:35], v[128:131]
    v_exp_f32 v101, v101
    v_mfma_f32_16x16x32_bf16 v[104:107], a[52:55], a[36:39], v[104:107]
    v_exp_f32 v102, v102
    v_mfma_f32_16x16x32_bf16 v[104:107], a[56:59], a[40:43], v[104:107]
    v_cvt_pk_bf16_f32 v114, v100, v101
    v_add_f32 v134, v134, v100
    v_mfma_f32_16x16x32_bf16 v[104:107], a[60:63], a[44:47], v[104:107]
    v_exp_f32 v103, v103
    v_mfma_f32_16x16x32_bf16 v[108:111], a[64:67], a[32:35], v[128:131]
    v_add_f32 v135, v135, v101
    v_add_f32 v134, v134, v102
    v_mfma_f32_16x16x32_bf16 v[108:111], a[68:71], a[36:39], v[108:111]
    v_cvt_pk_bf16_f32 v115, v102, v103
    v_add_f32 v135, v135, v103
    v_mfma_f32_16x16x32_bf16 v[108:111], a[72:75], a[40:43], v[108:111]
    ds_read_b128 a[48:51], v138 offset:16896
    ds_read_b128 a[52:55], v138 offset:16960
    v_mfma_f32_16x16x32_bf16 v[108:111], a[76:79], a[44:47], v[108:111]
    ds_read_b128 a[56:59], v138 offset:17024
    ds_read_b128 a[60:63], v138 offset:17088
    v_mfma_f32_16x16x32_bf16 v[4:7], a[80:83], v[112:115], v[4:7]
    v_exp_f32 v104, v104
    v_mfma_f32_16x16x32_bf16 v[16:19], a[84:87], v[112:115], v[16:19]
    ds_read_b128 a[64:67], v138 offset:17408
    v_exp_f32 v105, v105
    v_mfma_f32_16x16x32_bf16 v[28:31], a[88:91], v[112:115], v[28:31]
    ds_read_b128 a[68:71], v138 offset:17472
    v_exp_f32 v106, v106
    v_mfma_f32_16x16x32_bf16 v[40:43], a[92:95], v[112:115], v[40:43]
    v_cvt_pk_bf16_f32 v116, v104, v105
    v_add_f32 v136, v136, v104
    v_mfma_f32_16x16x32_bf16 v[52:55], a[96:99], v[112:115], v[52:55]
    ds_read_b128 a[72:75], v138 offset:17536
    v_exp_f32 v107, v107
    v_mfma_f32_16x16x32_bf16 v[64:67], a[100:103], v[112:115], v[64:67]
    v_exp_f32 v108, v108
    v_mfma_f32_16x16x32_bf16 v[76:79], a[104:107], v[112:115], v[76:79]
    v_cvt_pk_bf16_f32 v117, v106, v107
    v_add_f32 v137, v137, v105
    v_mfma_f32_16x16x32_bf16 v[88:91], a[108:111], v[112:115], v[88:91]
    ds_read_b128 a[76:79], v138 offset:17600
    v_add_f32 v136, v136, v106
    v_add_f32 v137, v137, v107
    s_waitcnt lgkmcnt(4)
    v_mfma_f32_16x16x32_bf16 v[96:99], a[48:51], a[0:3], v[120:123]
    v_exp_f32 v109, v109
    v_mfma_f32_16x16x32_bf16 v[96:99], a[52:55], a[4:7], v[96:99]
    v_exp_f32 v110, v110
    v_mfma_f32_16x16x32_bf16 v[96:99], a[56:59], a[8:11], v[96:99]
    v_cvt_pk_bf16_f32 v118, v108, v109
    v_add_f32 v136, v136, v108
    v_mfma_f32_16x16x32_bf16 v[96:99], a[60:63], a[12:15], v[96:99]
    v_exp_f32 v111, v111
    s_waitcnt lgkmcnt(0)
    v_mfma_f32_16x16x32_bf16 v[100:103], a[64:67], a[0:3], v[120:123]
    v_add_f32 v137, v137, v109
    v_add_f32 v136, v136, v110
    v_mfma_f32_16x16x32_bf16 v[100:103], a[68:71], a[4:7], v[100:103]
    v_cvt_pk_bf16_f32 v119, v110, v111
    v_add_f32 v137, v137, v111
    v_mfma_f32_16x16x32_bf16 v[100:103], a[72:75], a[8:11], v[100:103]
    v_add_u32 v139, s45, v139
    v_mfma_f32_16x16x32_bf16 v[100:103], a[76:79], a[12:15], v[100:103]
    v_add_u32 v138, s45, v138
    s_barrier
    v_mfma_f32_16x16x32_bf16 v[8:11], a[80:83], v[116:119], v[8:11]
    ds_read_b64_tr_b16 a[80:81], v139 offset:0
    v_exp_f32 v96, v96
    v_mfma_f32_16x16x32_bf16 v[20:23], a[84:87], v[116:119], v[20:23]
    ds_read_b64_tr_b16 a[82:83], v139 offset:512
    v_exp_f32 v97, v97
    v_mfma_f32_16x16x32_bf16 v[32:35], a[88:91], v[116:119], v[32:35]
    ds_read_b64_tr_b16 a[84:85], v139 offset:32
    v_exp_f32 v98, v98
    v_mfma_f32_16x16x32_bf16 v[44:47], a[92:95], v[116:119], v[44:47]
    ds_read_b64_tr_b16 a[86:87], v139 offset:544
    v_cvt_pk_bf16_f32 v112, v96, v97
    v_add_f32 v132, v132, v96
    v_mfma_f32_16x16x32_bf16 v[56:59], a[96:99], v[116:119], v[56:59]
    ds_read_b64_tr_b16 a[88:89], v139 offset:64
    v_exp_f32 v99, v99
    v_mfma_f32_16x16x32_bf16 v[68:71], a[100:103], v[116:119], v[68:71]
    ds_read_b64_tr_b16 a[90:91], v139 offset:576
    v_exp_f32 v100, v100
    v_mfma_f32_16x16x32_bf16 v[80:83], a[104:107], v[116:119], v[80:83]
    ds_read_b64_tr_b16 a[92:93], v139 offset:96
    v_cvt_pk_bf16_f32 v113, v98, v99
    v_add_f32 v133, v133, v97
    v_mfma_f32_16x16x32_bf16 v[92:95], a[108:111], v[116:119], v[92:95]
    ds_read_b64_tr_b16 a[94:95], v139 offset:608
    v_add_f32 v132, v132, v98
    v_add_f32 v133, v133, v99
L_k0_3:
    v_mfma_f32_16x16x32_bf16 v[104:107], a[48:51], a[16:19], v[124:127]
    ds_read_b64_tr_b16 a[96:97], v139 offset:128
    v_exp_f32 v101, v101
    v_mfma_f32_16x16x32_bf16 v[104:107], a[52:55], a[20:23], v[104:107]
    ds_read_b64_tr_b16 a[98:99], v139 offset:640
    v_exp_f32 v102, v102
    v_mfma_f32_16x16x32_bf16 v[104:107], a[56:59], a[24:27], v[104:107]
    ds_read_b64_tr_b16 a[100:101], v139 offset:160
    v_cvt_pk_bf16_f32 v114, v100, v101
    v_add_f32 v132, v132, v100
    v_mfma_f32_16x16x32_bf16 v[104:107], a[60:63], a[28:31], v[104:107]
    ds_read_b64_tr_b16 a[102:103], v139 offset:672
    v_exp_f32 v103, v103
    v_mfma_f32_16x16x32_bf16 v[108:111], a[64:67], a[16:19], v[124:127]
    ds_read_b64_tr_b16 a[104:105], v139 offset:192
    v_add_f32 v133, v133, v101
    v_add_f32 v132, v132, v102
    v_mfma_f32_16x16x32_bf16 v[108:111], a[68:71], a[20:23], v[108:111]
    ds_read_b64_tr_b16 a[106:107], v139 offset:704
    v_cvt_pk_bf16_f32 v115, v102, v103
    v_add_f32 v133, v133, v103
    v_mfma_f32_16x16x32_bf16 v[108:111], a[72:75], a[24:27], v[108:111]
    ds_read_b64_tr_b16 a[108:109], v139 offset:224
    v_mfma_f32_16x16x32_bf16 v[108:111], a[76:79], a[28:31], v[108:111]
    ds_read_b64_tr_b16 a[110:111], v139 offset:736
    s_waitcnt lgkmcnt(8)
    v_mfma_f32_16x16x32_bf16 v[0:3], a[80:83], v[112:115], v[0:3]
    v_exp_f32 v104, v104
    v_mfma_f32_16x16x32_bf16 v[12:15], a[84:87], v[112:115], v[12:15]
    v_exp_f32 v105, v105
    v_mfma_f32_16x16x32_bf16 v[24:27], a[88:91], v[112:115], v[24:27]
    v_exp_f32 v106, v106
    v_mfma_f32_16x16x32_bf16 v[36:39], a[92:95], v[112:115], v[36:39]
    v_cvt_pk_bf16_f32 v116, v104, v105
    v_add_f32 v134, v134, v104
    s_waitcnt lgkmcnt(0)
    v_mfma_f32_16x16x32_bf16 v[48:51], a[96:99], v[112:115], v[48:51]
    v_exp_f32 v107, v107
    v_mfma_f32_16x16x32_bf16 v[60:63], a[100:103], v[112:115], v[60:63]
    v_exp_f32 v108, v108
    v_mfma_f32_16x16x32_bf16 v[72:75], a[104:107], v[112:115], v[72:75]
    v_cvt_pk_bf16_f32 v117, v106, v107
    v_add_f32 v135, v135, v105
    v_mfma_f32_16x16x32_bf16 v[84:87], a[108:111], v[112:115], v[84:87]
    v_add_f32 v134, v134, v106
    v_add_f32 v135, v135, v107
    v_mfma_f32_16x16x32_bf16 v[96:99], a[48:51], a[32:35], v[128:131]
    v_exp_f32 v109, v109
    v_mfma_f32_16x16x32_bf16 v[96:99], a[52:55], a[36:39], v[96:99]
    v_exp_f32 v110, v110
    v_mfma_f32_16x16x32_bf16 v[96:99], a[56:59], a[40:43], v[96:99]
    v_cvt_pk_bf16_f32 v118, v108, v109
    v_add_f32 v134, v134, v108
    v_mfma_f32_16x16x32_bf16 v[96:99], a[60:63], a[44:47], v[96:99]
    v_exp_f32 v111, v111
    v_mfma_f32_16x16x32_bf16 v[100:103], a[64:67], a[32:35], v[128:131]
    v_add_f32 v135, v135, v109
    v_add_f32 v134, v134, v110
    v_mfma_f32_16x16x32_bf16 v[100:103], a[68:71], a[36:39], v[100:103]
    v_cvt_pk_bf16_f32 v119, v110, v111
    v_add_f32 v135, v135, v111
    v_mfma_f32_16x16x32_bf16 v[100:103], a[72:75], a[40:43], v[100:103]
    ds_read_b128 a[48:51], v138 offset:0
    ds_read_b128 a[52:55], v138 offset:64
    v_mfma_f32_16x16x32_bf16 v[100:103], a[76:79], a[44:47], v[100:103]
    ds_read_b128 a[56:59], v138 offset:128
    ds_read_b128 a[60:63], v138 offset:192
    v_mfma_f32_16x16x32_bf16 v[4:7], a[80:83], v[116:119], v[4:7]
    v_exp_f32 v96, v96
    v_mfma_f32_16x16x32_bf16 v[16:19], a[84:87], v[116:119], v[16:19]
    ds_read_b128 a[64:67], v138 offset:512
    v_exp_f32 v97, v97
    v_mfma_f32_16x16x32_bf16 v[28:31], a[88:91], v[116:119], v[28:31]
    ds_read_b128 a[68:71], v138 offset:576
    v_exp_f32 v98, v98
    v_mfma_f32_16x16x32_bf16 v[40:43], a[92:95], v[116:119], v[40:43]
    v_cvt_pk_bf16_f32 v112, v96, v97
    v_add_f32 v136, v136, v96
    v_mfma_f32_16x16x32_bf16 v[52:55], a[96:99], v[116:119], v[52:55]
    ds_read_b128 a[72:75], v138 offset:640
    v_exp_f32 v99, v99
    v_mfma_f32_16x16x32_bf16 v[64:67], a[100:103], v[116:119], v[64:67]
    v_exp_f32 v100, v100
    v_mfma_f32_16x16x32_bf16 v[76:79], a[104:107], v[116:119], v[76:79]
    v_cvt_pk_bf16_f32 v113, v98, v99
    v_add_f32 v137, v137, v97
    v_mfma_f32_16x16x32_bf16 v[88:91], a[108:111], v[116:119], v[88:91]
    ds_read_b128 a[76:79], v138 offset:704
    v_add_f32 v136, v136, v98
    v_add_f32 v137, v137, v99
    s_waitcnt lgkmcnt(4)
    v_mfma_f32_16x16x32_bf16 v[104:107], a[48:51], a[0:3], v[120:123]
    v_exp_f32 v101, v101
    v_mfma_f32_16x16x32_bf16 v[104:107], a[52:55], a[4:7], v[104:107]
    v_exp_f32 v102, v102
    v_mfma_f32_16x16x32_bf16 v[104:107], a[56:59], a[8:11], v[104:107]
    v_cvt_pk_bf16_f32 v114, v100, v101
    v_add_f32 v136, v136, v100
    v_mfma_f32_16x16x32_bf16 v[104:107], a[60:63], a[12:15], v[104:107]
    v_exp_f32 v103, v103
    s_waitcnt lgkmcnt(0)
    v_mfma_f32_16x16x32_bf16 v[108:111], a[64:67], a[0:3], v[120:123]
    v_add_f32 v137, v137, v101
    v_add_f32 v136, v136, v102
    v_mfma_f32_16x16x32_bf16 v[108:111], a[68:71], a[4:7], v[108:111]
    v_cvt_pk_bf16_f32 v115, v102, v103
    v_add_f32 v137, v137, v103
    v_mfma_f32_16x16x32_bf16 v[108:111], a[72:75], a[8:11], v[108:111]
    v_mfma_f32_16x16x32_bf16 v[108:111], a[76:79], a[12:15], v[108:111]
    s_barrier
    v_mfma_f32_16x16x32_bf16 v[8:11], a[80:83], v[112:115], v[8:11]
    ds_read_b64_tr_b16 a[80:81], v139 offset:16896
    v_exp_f32 v104, v104
    v_mfma_f32_16x16x32_bf16 v[20:23], a[84:87], v[112:115], v[20:23]
    ds_read_b64_tr_b16 a[82:83], v139 offset:17408
    v_exp_f32 v105, v105
    v_mfma_f32_16x16x32_bf16 v[32:35], a[88:91], v[112:115], v[32:35]
    ds_read_b64_tr_b16 a[84:85], v139 offset:16928
    v_exp_f32 v106, v106
    v_mfma_f32_16x16x32_bf16 v[44:47], a[92:95], v[112:115], v[44:47]
    ds_read_b64_tr_b16 a[86:87], v139 offset:17440
    v_cvt_pk_bf16_f32 v116, v104, v105
    v_add_f32 v132, v132, v104
    v_mfma_f32_16x16x32_bf16 v[56:59], a[96:99], v[112:115], v[56:59]
    ds_read_b64_tr_b16 a[88:89], v139 offset:16960
    v_exp_f32 v107, v107
    v_mfma_f32_16x16x32_bf16 v[68:71], a[100:103], v[112:115], v[68:71]
    ds_read_b64_tr_b16 a[90:91], v139 offset:17472
    v_exp_f32 v108, v108
    v_mfma_f32_16x16x32_bf16 v[80:83], a[104:107], v[112:115], v[80:83]
    ds_read_b64_tr_b16 a[92:93], v139 offset:16992
    v_cvt_pk_bf16_f32 v117, v106, v107
    v_add_f32 v133, v133, v105
    v_mfma_f32_16x16x32_bf16 v[92:95], a[108:111], v[112:115], v[92:95]
    ds_read_b64_tr_b16 a[94:95], v139 offset:17504
    v_add_f32 v132, v132, v106
    v_add_f32 v133, v133, v107
    v_mfma_f32_16x16x32_bf16 v[96:99], a[48:51], a[16:19], v[124:127]
    ds_read_b64_tr_b16 a[96:97], v139 offset:17024
    v_exp_f32 v109, v109
    v_mfma_f32_16x16x32_bf16 v[96:99], a[52:55], a[20:23], v[96:99]
    ds_read_b64_tr_b16 a[98:99], v139 offset:17536
    v_exp_f32 v110, v110
    v_mfma_f32_16x16x32_bf16 v[96:99], a[56:59], a[24:27], v[96:99]
    ds_read_b64_tr_b16 a[100:101], v139 offset:17056
    v_cvt_pk_bf16_f32 v118, v108, v109
    v_add_f32 v132, v132, v108
    v_mfma_f32_16x16x32_bf16 v[96:99], a[60:63], a[28:31], v[96:99]
    ds_read_b64_tr_b16 a[102:103], v139 offset:17568
    v_exp_f32 v111, v111
    v_mfma_f32_16x16x32_bf16 v[100:103], a[64:67], a[16:19], v[124:127]
    ds_read_b64_tr_b16 a[104:105], v139 offset:17088
    v_add_f32 v133, v133, v109
    v_add_f32 v132, v132, v110
    v_mfma_f32_16x16x32_bf16 v[100:103], a[68:71], a[20:23], v[100:103]
    ds_read_b64_tr_b16 a[106:107], v139 offset:17600
    v_cvt_pk_bf16_f32 v119, v110, v111
    v_add_f32 v133, v133, v111
    v_mfma_f32_16x16x32_bf16 v[100:103], a[72:75], a[24:27], v[100:103]
    ds_read_b64_tr_b16 a[108:109], v139 offset:17120
    v_mfma_f32_16x16x32_bf16 v[100:103], a[76:79], a[28:31], v[100:103]
    ds_read_b64_tr_b16 a[110:111], v139 offset:17632
    s_waitcnt lgkmcnt(8)
    v_mfma_f32_16x16x32_bf16 v[0:3], a[80:83], v[116:119], v[0:3]
    s_add_u32 s44, s44, 1
    v_exp_f32 v96, v96
    v_mfma_f32_16x16x32_bf16 v[12:15], a[84:87], v[116:119], v[12:15]
    s_and_b32 s46, s44, 3
    v_exp_f32 v97, v97
    v_mfma_f32_16x16x32_bf16 v[24:27], a[88:91], v[116:119], v[24:27]
    s_cselect_b32 s45, s54, 4294865920
    v_exp_f32 v98, v98
    v_mfma_f32_16x16x32_bf16 v[36:39], a[92:95], v[116:119], v[36:39]
    v_cvt_pk_bf16_f32 v112, v96, v97
    v_add_f32 v134, v134, v96
    s_waitcnt lgkmcnt(0)
    v_mfma_f32_16x16x32_bf16 v[48:51], a[96:99], v[116:119], v[48:51]
    s_cmp_lt_u32 s44, 8
    v_exp_f32 v99, v99
    v_mfma_f32_16x16x32_bf16 v[60:63], a[100:103], v[116:119], v[60:63]
    v_exp_f32 v100, v100
    v_mfma_f32_16x16x32_bf16 v[72:75], a[104:107], v[116:119], v[72:75]
    v_cvt_pk_bf16_f32 v113, v98, v99
    v_add_f32 v135, v135, v97
    v_mfma_f32_16x16x32_bf16 v[84:87], a[108:111], v[116:119], v[84:87]
    v_add_f32 v134, v134, v98
    v_add_f32 v135, v135, v99
    s_cbranch_scc1 L_loop3
L_tail:
    buffer_load_dword v140, off, s[32:35], s62 sc1
    v_mfma_f32_16x16x32_bf16 v[104:107], a[48:51], a[32:35], v[128:131]
    v_exp_f32 v101, v101
    v_mfma_f32_16x16x32_bf16 v[104:107], a[52:55], a[36:39], v[104:107]
    v_exp_f32 v102, v102
    v_mfma_f32_16x16x32_bf16 v[104:107], a[56:59], a[40:43], v[104:107]
    v_cvt_pk_bf16_f32 v114, v100, v101
    v_add_f32 v134, v134, v100
    v_mfma_f32_16x16x32_bf16 v[104:107], a[60:63], a[44:47], v[104:107]
    v_exp_f32 v103, v103
    v_cvt_pk_bf16_f32 v24, v24, v25
    v_cvt_pk_bf16_f32 v25, v26, v27
    v_mfma_f32_16x16x32_bf16 v[108:111], a[64:67], a[32:35], v[128:131]
    v_add_f32 v135, v135, v101
    v_add_f32 v134, v134, v102
    v_cvt_pk_bf16_f32 v26, v36, v37
    v_cvt_pk_bf16_f32 v27, v38, v39
    v_mfma_f32_16x16x32_bf16 v[108:111], a[68:71], a[36:39], v[108:111]
    buffer_store_dwordx4 v[24:27], v143, s[28:31], s56 offen offset:0 sc1
    v_cvt_pk_bf16_f32 v115, v102, v103
    v_add_f32 v135, v135, v103
    v_mfma_f32_16x16x32_bf16 v[108:111], a[72:75], a[40:43], v[108:111]
    v_cvt_pk_bf16_f32 v48, v48, v49
    v_cvt_pk_bf16_f32 v49, v50, v51
    v_cvt_pk_bf16_f32 v50, v60, v61
    v_cvt_pk_bf16_f32 v51, v62, v63
    v_mfma_f32_16x16x32_bf16 v[108:111], a[76:79], a[44:47], v[108:111]
    buffer_store_dwordx4 v[48:51], v143, s[28:31], s57 offen offset:0 sc1
    v_cvt_pk_bf16_f32 v72, v72, v73
    v_cvt_pk_bf16_f32 v73, v74, v75
    v_cvt_pk_bf16_f32 v74, v84, v85
    v_cvt_pk_bf16_f32 v75, v86, v87
    v_mfma_f32_16x16x32_bf16 v[4:7], a[80:83], v[112:115], v[4:7]
    buffer_store_dwordx4 v[72:75], v143, s[28:31], s58 offen offset:0 sc1
    v_exp_f32 v104, v104
    v_mfma_f32_16x16x32_bf16 v[16:19], a[84:87], v[112:115], v[16:19]
    v_exp_f32 v105, v105
    v_mfma_f32_16x16x32_bf16 v[28:31], a[88:91], v[112:115], v[28:31]
    v_exp_f32 v106, v106
    v_mfma_f32_16x16x32_bf16 v[40:43], a[92:95], v[112:115], v[40:43]
    v_cvt_pk_bf16_f32 v116, v104, v105
    v_add_f32 v136, v136, v104
    v_mfma_f32_16x16x32_bf16 v[52:55], a[96:99], v[112:115], v[52:55]
    v_exp_f32 v107, v107
    v_mfma_f32_16x16x32_bf16 v[64:67], a[100:103], v[112:115], v[64:67]
    v_exp_f32 v108, v108
    v_mfma_f32_16x16x32_bf16 v[76:79], a[104:107], v[112:115], v[76:79]
    v_cvt_pk_bf16_f32 v117, v106, v107
    v_add_f32 v137, v137, v105
    v_mfma_f32_16x16x32_bf16 v[88:91], a[108:111], v[112:115], v[88:91]
    v_add_f32 v136, v136, v106
    v_add_f32 v137, v137, v107
    v_exp_f32 v109, v109
    v_exp_f32 v110, v110
    v_cvt_pk_bf16_f32 v28, v28, v29
    v_cvt_pk_bf16_f32 v29, v30, v31
    v_cvt_pk_bf16_f32 v30, v40, v41
    v_cvt_pk_bf16_f32 v31, v42, v43
    buffer_store_dwordx4 v[28:31], v143, s[28:31], s56 offen offset:1024
    v_cvt_pk_bf16_f32 v118, v108, v109
    v_add_f32 v136, v136, v108
    v_exp_f32 v111, v111
    v_cvt_pk_bf16_f32 v52, v52, v53
    v_cvt_pk_bf16_f32 v53, v54, v55
    v_cvt_pk_bf16_f32 v54, v64, v65
    v_cvt_pk_bf16_f32 v55, v66, v67
    buffer_store_dwordx4 v[52:55], v143, s[28:31], s57 offen offset:1024
    v_add_f32 v137, v137, v109
    v_add_f32 v136, v136, v110
    v_cvt_pk_bf16_f32 v119, v110, v111
    v_add_f32 v137, v137, v111
    v_cvt_pk_bf16_f32 v76, v76, v77
    v_cvt_pk_bf16_f32 v77, v78, v79
    v_cvt_pk_bf16_f32 v78, v88, v89
    v_cvt_pk_bf16_f32 v79, v90, v91
    buffer_store_dwordx4 v[76:79], v143, s[28:31], s58 offen offset:1024
    s_nop 0
    v_mfma_f32_16x16x32_bf16 v[32:35], a[88:91], v[116:119], v[32:35]
    v_add_f32 v96, v132, v133
    v_add_f32 v97, v134, v135
    v_add_f32 v98, v136, v137
    v_mov_b32 v100, v96
    v_mov_b32 v101, v97
    v_mov_b32 v102, v98
    v_mfma_f32_16x16x32_bf16 v[44:47], a[92:95], v[116:119], v[44:47]
    s_nop 0
    v_permlane32_swap_b32 v96, v100
    v_permlane32_swap_b32 v97, v101
    v_permlane32_swap_b32 v98, v102
    s_nop 0
    v_add_f32 v96, v96, v100
    v_mfma_f32_16x16x32_bf16 v[56:59], a[96:99], v[116:119], v[56:59]
    v_add_f32 v97, v97, v101
    v_add_f32 v98, v98, v102
    v_mov_b32 v100, v96
    v_mov_b32 v101, v97
    v_mov_b32 v102, v98
    s_nop 0
    v_mfma_f32_16x16x32_bf16 v[68:71], a[100:103], v[116:119], v[68:71]
    v_permlane16_swap_b32 v96, v100
    v_permlane16_swap_b32 v97, v101
    v_permlane16_swap_b32 v98, v102
    s_nop 0
    v_add_f32 v96, v96, v100
    v_add_f32 v97, v97, v101
    v_mfma_f32_16x16x32_bf16 v[80:83], a[104:107], v[116:119], v[80:83]
    v_add_f32 v98, v98, v102
    v_mov_b32 v99, 0
    buffer_store_dwordx4 v[96:99], v142, s[28:31], s59 offen
    v_add_f32 v141, v96, v97
    s_mov_b32 s50, 0x5f800000
    v_add_f32 v141, v141, v98
    v_cmp_nlt_f32 vcc, v141, s50
    v_mfma_f32_16x16x32_bf16 v[92:95], a[108:111], v[116:119], v[92:95]
    v_cvt_pk_bf16_f32 v32, v32, v33
    v_cvt_pk_bf16_f32 v33, v34, v35
    v_cvt_pk_bf16_f32 v34, v44, v45
    v_cvt_pk_bf16_f32 v35, v46, v47
    buffer_store_dwordx4 v[32:35], v143, s[28:31], s56 offen offset:2048
    v_mfma_f32_16x16x32_bf16 v[8:11], a[80:83], v[116:119], v[8:11]
    v_mfma_f32_16x16x32_bf16 v[20:23], a[84:87], v[116:119], v[20:23]
    v_cvt_pk_bf16_f32 v56, v56, v57
    v_cvt_pk_bf16_f32 v57, v58, v59
    v_cvt_pk_bf16_f32 v58, v68, v69
    v_cvt_pk_bf16_f32 v59, v70, v71
    buffer_store_dwordx4 v[56:59], v143, s[28:31], s57 offen offset:2048
    v_cvt_pk_bf16_f32 v80, v80, v81
    v_cvt_pk_bf16_f32 v81, v82, v83
    v_cvt_pk_bf16_f32 v82, v92, v93
    v_cvt_pk_bf16_f32 v83, v94, v95
    buffer_store_dwordx4 v[80:83], v143, s[28:31], s58 offen offset:2048
    s_cbranch_vccz L_sent
    s_waitcnt vmcnt(0)
    s_branch L_slow
L_sent:
    s_mov_b32 s47, 0x100000
    s_waitcnt vmcnt(10)
L_hs:
    v_readfirstlane_b32 s44, v140
    s_and_b32 s45, s44, 0x80808080
    s_cmp_eq_u32 s45, 0x80808080
    s_cbranch_scc0 L_hs_retry
L_hs_ok:
    s_lshr_b32 s45, s44, 8
    s_xor_b32 s45, s45, s44
    s_and_b32 s45, s45, 0x00707070
    v_bfe_u32 v100, v143, 4, 2
    v_lshlrev_b32 v101, 3, v100
    v_add_u32 v101, s19, v101
    v_lshrrev_b32 v101, v101, s44
    v_and_b32 v101, 1, v101
    v_lshlrev_b32 v100, 2, v100
    s_lshl_b32 s46, s17, 3
    s_add_u32 s46, s46, s19
    s_lshr_b32 s46, s44, s46
    s_and_b32 s46, s46, 1
    v_mov_b32 v102, s46
    s_lshl_b32 s46, s17, 2
    s_add_u32 s46, s46, s61
    s_xor_b32 s20, s59, 512
    s_xor_b32 s21, s59, 1024
    s_xor_b32 s22, s59, 1536
    s_add_u32 s40, s60, 3072
    s_add_u32 s41, s60, 6144
    s_mov_b32 s47, 0x100000
    s_cmp_lg_u32 s45, 0
    s_waitcnt vmcnt(0)
    s_cbranch_scc1 L_xcd_flag
    buffer_store_dword v102, off, s[28:31], s46
L_poll:
    buffer_load_dword v103, v100, s[28:31], s61 offen nt
    s_waitcnt vmcnt(0)
    v_and_b32 v103, 1, v103
    v_cmp_ne_u32 vcc, v103, v101
    s_cbranch_vccz L_poll_ok
    s_sub_u32 s47, s47, 1
    s_cbranch_scc0 L_poll
L_poll_ok:
    buffer_load_dwordx4 v[104:107], v142, s[28:31], s20 offen nt
    buffer_load_dwordx4 v[108:111], v142, s[28:31], s21 offen nt
    buffer_load_dwordx4 v[112:115], v142, s[28:31], s22 offen nt
    buffer_load_dwordx4 v[24:27], v143, s[28:31], s60 offen offset:0 nt
    buffer_load_dwordx4 v[36:39], v143, s[28:31], s40 offen offset:0 nt
    buffer_load_dwordx4 v[48:51], v143, s[28:31], s41 offen offset:0 nt
    buffer_load_dwordx4 v[28:31], v143, s[28:31], s60 offen offset:1024 nt
    buffer_load_dwordx4 v[40:43], v143, s[28:31], s40 offen offset:1024 nt
    buffer_load_dwordx4 v[52:55], v143, s[28:31], s41 offen offset:1024 nt
    buffer_load_dwordx4 v[32:35], v143, s[28:31], s60 offen offset:2048 nt
    buffer_load_dwordx4 v[44:47], v143, s[28:31], s40 offen offset:2048 nt
    buffer_load_dwordx4 v[56:59], v143, s[28:31], s41 offen offset:2048 nt
L_loaded:
    v_bfe_u32 v132, v143, 4, 4
    v_lshlrev_b32 v132, 8, v132
    v_bfe_u32 v133, v143, 8, 1
    v_lshlrev_b32 v133, 5, v133
    v_bfe_u32 v134, v143, 9, 1
    v_lshl_add_u32 v133, v134, 4, v133
    s_lshl_b32 s42, s17, 6
    v_add3_u32 v132, v132, v133, s42
    s_waitcnt vmcnt(9)
    v_or3_b32 v99, v99, v107, v111
    v_or_b32 v99, v99, v115
    v_cmp_ne_u32 vcc, 0, v99
    s_cbranch_vccnz L_general
    v_add_f32 v96, v96, v104
    v_add_f32 v97, v97, v105
    v_add_f32 v98, v98, v106
    v_add_f32 v96, v96, v108
    v_add_f32 v97, v97, v109
    v_add_f32 v98, v98, v110
    v_add_f32 v96, v96, v112
    v_add_f32 v97, v97, v113
    v_add_f32 v98, v98, v114
    v_rcp_f32 v96, v96
    v_rcp_f32 v97, v97
    v_rcp_f32 v98, v98
    s_waitcnt vmcnt(8)
    v_dot2c_f32_bf16 v0, s48, v24
    v_dot2c_f32_bf16 v1, s49, v24
    v_dot2c_f32_bf16 v2, s48, v25
    v_dot2c_f32_bf16 v3, s49, v25
    v_dot2c_f32_bf16 v12, s48, v26
    v_dot2c_f32_bf16 v13, s49, v26
    v_dot2c_f32_bf16 v14, s48, v27
    v_dot2c_f32_bf16 v15, s49, v27
    s_waitcnt vmcnt(7)
    v_dot2c_f32_bf16 v0, s48, v36
    v_dot2c_f32_bf16 v1, s49, v36
    v_dot2c_f32_bf16 v2, s48, v37
    v_dot2c_f32_bf16 v3, s49, v37
    v_dot2c_f32_bf16 v12, s48, v38
    v_dot2c_f32_bf16 v13, s49, v38
    v_dot2c_f32_bf16 v14, s48, v39
    v_dot2c_f32_bf16 v15, s49, v39
    s_waitcnt vmcnt(6)
    v_dot2c_f32_bf16 v0, s48, v48
    v_dot2c_f32_bf16 v1, s49, v48
    v_dot2c_f32_bf16 v2, s48, v49
    v_dot2c_f32_bf16 v3, s49, v49
    v_dot2c_f32_bf16 v12, s48, v50
    v_dot2c_f32_bf16 v13, s49, v50
    v_dot2c_f32_bf16 v14, s48, v51
    v_dot2c_f32_bf16 v15, s49, v51
    v_mul_f32 v0, v0, v96
    v_mul_f32 v1, v1, v96
    v_mul_f32 v2, v2, v96
    v_mul_f32 v3, v3, v96
    v_mul_f32 v12, v12, v96
    v_mul_f32 v13, v13, v96
    v_mul_f32 v14, v14, v96
    v_mul_f32 v15, v15, v96
    v_cvt_pk_bf16_f32 v0, v0, v1
    v_cvt_pk_bf16_f32 v1, v2, v3
    v_cvt_pk_bf16_f32 v2, v12, v13
    v_cvt_pk_bf16_f32 v3, v14, v15
    s_nop 0
    v_permlane16_swap_b32 v0, v2
    v_permlane16_swap_b32 v1, v3
    s_nop 0
    buffer_store_dwordx4 v[0:3], v132, s[24:27], 0 offen sc1
    s_waitcnt vmcnt(6)
    v_dot2c_f32_bf16 v4, s48, v28
    v_dot2c_f32_bf16 v5, s49, v28
    v_dot2c_f32_bf16 v6, s48, v29
    v_dot2c_f32_bf16 v7, s49, v29
    v_dot2c_f32_bf16 v16, s48, v30
    v_dot2c_f32_bf16 v17, s49, v30
    v_dot2c_f32_bf16 v18, s48, v31
    v_dot2c_f32_bf16 v19, s49, v31
    s_waitcnt vmcnt(5)
    v_dot2c_f32_bf16 v4, s48, v40
    v_dot2c_f32_bf16 v5, s49, v40
    v_dot2c_f32_bf16 v6, s48, v41
    v_dot2c_f32_bf16 v7, s49, v41
    v_dot2c_f32_bf16 v16, s48, v42
    v_dot2c_f32_bf16 v17, s49, v42
    v_dot2c_f32_bf16 v18, s48, v43
    v_dot2c_f32_bf16 v19, s49, v43
    s_waitcnt vmcnt(4)
    v_dot2c_f32_bf16 v4, s48, v52
    v_dot2c_f32_bf16 v5, s49, v52
    v_dot2c_f32_bf16 v6, s48, v53
    v_dot2c_f32_bf16 v7, s49, v53
    v_dot2c_f32_bf16 v16, s48, v54
    v_dot2c_f32_bf16 v17, s49, v54
    v_dot2c_f32_bf16 v18, s48, v55
    v_dot2c_f32_bf16 v19, s49, v55
    v_mul_f32 v4, v4, v97
    v_mul_f32 v5, v5, v97
    v_mul_f32 v6, v6, v97
    v_mul_f32 v7, v7, v97
    v_mul_f32 v16, v16, v97
    v_mul_f32 v17, v17, v97
    v_mul_f32 v18, v18, v97
    v_mul_f32 v19, v19, v97
    v_cvt_pk_bf16_f32 v4, v4, v5
    v_cvt_pk_bf16_f32 v5, v6, v7
    v_cvt_pk_bf16_f32 v6, v16, v17
    v_cvt_pk_bf16_f32 v7, v18, v19
    s_nop 0
    v_permlane16_swap_b32 v4, v6
    v_permlane16_swap_b32 v5, v7
    s_nop 0
    buffer_store_dwordx4 v[4:7], v132, s[24:27], s38 offen sc1
    s_waitcnt vmcnt(4)
    v_dot2c_f32_bf16 v8, s48, v32
    v_dot2c_f32_bf16 v9, s49, v32
    v_dot2c_f32_bf16 v10, s48, v33
    v_dot2c_f32_bf16 v11, s49, v33
    v_dot2c_f32_bf16 v20, s48, v34
    v_dot2c_f32_bf16 v21, s49, v34
    v_dot2c_f32_bf16 v22, s48, v35
    v_dot2c_f32_bf16 v23, s49, v35
    s_waitcnt vmcnt(3)
    v_dot2c_f32_bf16 v8, s48, v44
    v_dot2c_f32_bf16 v9, s49, v44
    v_dot2c_f32_bf16 v10, s48, v45
    v_dot2c_f32_bf16 v11, s49, v45
    v_dot2c_f32_bf16 v20, s48, v46
    v_dot2c_f32_bf16 v21, s49, v46
    v_dot2c_f32_bf16 v22, s48, v47
    v_dot2c_f32_bf16 v23, s49, v47
    s_waitcnt vmcnt(2)
    v_dot2c_f32_bf16 v8, s48, v56
    v_dot2c_f32_bf16 v9, s49, v56
    v_dot2c_f32_bf16 v10, s48, v57
    v_dot2c_f32_bf16 v11, s49, v57
    v_dot2c_f32_bf16 v20, s48, v58
    v_dot2c_f32_bf16 v21, s49, v58
    v_dot2c_f32_bf16 v22, s48, v59
    v_dot2c_f32_bf16 v23, s49, v59
    v_mul_f32 v8, v8, v98
    v_mul_f32 v9, v9, v98
    v_mul_f32 v10, v10, v98
    v_mul_f32 v11, v11, v98
    v_mul_f32 v20, v20, v98
    v_mul_f32 v21, v21, v98
    v_mul_f32 v22, v22, v98
    v_mul_f32 v23, v23, v98
    v_cvt_pk_bf16_f32 v8, v8, v9
    v_cvt_pk_bf16_f32 v9, v10, v11
    v_cvt_pk_bf16_f32 v10, v20, v21
    v_cvt_pk_bf16_f32 v11, v22, v23
    s_nop 0
    v_permlane16_swap_b32 v8, v10
    v_permlane16_swap_b32 v9, v11
    s_nop 0
    buffer_store_dwordx4 v[8:11], v132, s[24:27], s39 offen sc1
L_done:
L_end:
    s_endpgm
L_hs_retry:
    s_sleep 2
    buffer_load_dword v140, off, s[32:35], s62 sc1
    s_sub_u32 s47, s47, 1
    s_waitcnt vmcnt(0)
    s_cbranch_scc0 L_hs
    s_branch L_hs_ok
L_xcd_flag:
    buffer_store_dwordx4 v[96:99], v142, s[28:31], s59 offen sc1
    buffer_store_dwordx4 v[24:27], v143, s[28:31], s56 offen offset:0 sc1
    buffer_store_dwordx4 v[48:51], v143, s[28:31], s57 offen offset:0 sc1
    buffer_store_dwordx4 v[72:75], v143, s[28:31], s58 offen offset:0 sc1
    buffer_store_dwordx4 v[28:31], v143, s[28:31], s56 offen offset:1024 sc1
    buffer_store_dwordx4 v[52:55], v143, s[28:31], s57 offen offset:1024 sc1
    buffer_store_dwordx4 v[76:79], v143, s[28:31], s58 offen offset:1024 sc1
    buffer_store_dwordx4 v[32:35], v143, s[28:31], s56 offen offset:2048 sc1
    buffer_store_dwordx4 v[56:59], v143, s[28:31], s57 offen offset:2048 sc1
    buffer_store_dwordx4 v[80:83], v143, s[28:31], s58 offen offset:2048 sc1
    s_waitcnt vmcnt(0)
    buffer_store_dword v102, off, s[28:31], s46 sc1
L_poll2:
    buffer_load_dword v103, v100, s[28:31], s61 offen sc1
    s_waitcnt vmcnt(0)
    v_and_b32 v103, 1, v103
    v_cmp_ne_u32 vcc, v103, v101
    s_cbranch_vccz L_poll2_ok
    s_sub_u32 s47, s47, 1
    s_cbranch_scc0 L_poll2
L_poll2_ok:
    buffer_load_dwordx4 v[104:107], v142, s[28:31], s20 offen sc1
    buffer_load_dwordx4 v[108:111], v142, s[28:31], s21 offen sc1
    buffer_load_dwordx4 v[112:115], v142, s[28:31], s22 offen sc1
    buffer_load_dwordx4 v[24:27], v143, s[28:31], s60 offen offset:0 sc1
    buffer_load_dwordx4 v[36:39], v143, s[28:31], s40 offen offset:0 sc1
    buffer_load_dwordx4 v[48:51], v143, s[28:31], s41 offen offset:0 sc1
    buffer_load_dwordx4 v[28:31], v143, s[28:31], s60 offen offset:1024 sc1
    buffer_load_dwordx4 v[40:43], v143, s[28:31], s40 offen offset:1024 sc1
    buffer_load_dwordx4 v[52:55], v143, s[28:31], s41 offen offset:1024 sc1
    buffer_load_dwordx4 v[32:35], v143, s[28:31], s60 offen offset:2048 sc1
    buffer_load_dwordx4 v[44:47], v143, s[28:31], s40 offen offset:2048 sc1
    buffer_load_dwordx4 v[56:59], v143, s[28:31], s41 offen offset:2048 sc1
    s_branch L_loaded
L_general:
    buffer_load_dwordx4 v[64:67], v142, s[28:31], s20 offen offset:256 sc1
    buffer_load_dwordx4 v[68:71], v142, s[28:31], s21 offen offset:256 sc1
    buffer_load_dwordx4 v[72:75], v142, s[28:31], s22 offen offset:256 sc1
    v_mov_b32 v60, v120
    v_mov_b32 v61, v124
    v_mov_b32 v62, v128
    s_waitcnt vmcnt(0)
    v_min3_f32 v100, v60, v64, v68
    v_min_f32 v100, v100, v72
    v_sub_f32 v60, v100, v60
    v_sub_f32 v64, v100, v64
    v_sub_f32 v68, v100, v68
    v_sub_f32 v72, v100, v72
    v_exp_f32 v60, v60
    v_exp_f32 v64, v64
    v_exp_f32 v68, v68
    v_exp_f32 v72, v72
    s_nop 0
    v_mul_f32 v96, v96, v60
    v_fmac_f32 v96, v64, v104
    v_fmac_f32 v96, v68, v108
    v_fmac_f32 v96, v72, v112
    v_min3_f32 v100, v61, v65, v69
    v_min_f32 v100, v100, v73
    v_sub_f32 v61, v100, v61
    v_sub_f32 v65, v100, v65
    v_sub_f32 v69, v100, v69
    v_sub_f32 v73, v100, v73
    v_exp_f32 v61, v61
    v_exp_f32 v65, v65
    v_exp_f32 v69, v69
    v_exp_f32 v73, v73
    s_nop 0
    v_mul_f32 v97, v97, v61
    v_fmac_f32 v97, v65, v105
    v_fmac_f32 v97, v69, v109
    v_fmac_f32 v97, v73, v113
    v_min3_f32 v100, v62, v66, v70
    v_min_f32 v100, v100, v74
    v_sub_f32 v62, v100, v62
    v_sub_f32 v66, v100, v66
    v_sub_f32 v70, v100, v70
    v_sub_f32 v74, v100, v74
    v_exp_f32 v62, v62
    v_exp_f32 v66, v66
    v_exp_f32 v70, v70
    v_exp_f32 v74, v74
    s_nop 0
    v_mul_f32 v98, v98, v62
    v_fmac_f32 v98, v66, v106
    v_fmac_f32 v98, v70, v110
    v_fmac_f32 v98, v74, v114
    v_rcp_f32 v96, v96
    v_rcp_f32 v97, v97
    v_rcp_f32 v98, v98
    v_mul_f32 v0, v0, v60
    v_mul_f32 v1, v1, v60
    v_mul_f32 v2, v2, v60
    v_mul_f32 v3, v3, v60
    v_mul_f32 v12, v12, v60
    v_mul_f32 v13, v13, v60
    v_mul_f32 v14, v14, v60
    v_mul_f32 v15, v15, v60
    v_lshlrev_b32 v116, 16, v24
    v_and_b32 v117, s51, v24
    v_fmac_f32 v0, v116, v64
    v_fmac_f32 v1, v117, v64
    v_lshlrev_b32 v116, 16, v25
    v_and_b32 v117, s51, v25
    v_fmac_f32 v2, v116, v64
    v_fmac_f32 v3, v117, v64
    v_lshlrev_b32 v116, 16, v26
    v_and_b32 v117, s51, v26
    v_fmac_f32 v12, v116, v64
    v_fmac_f32 v13, v117, v64
    v_lshlrev_b32 v116, 16, v27
    v_and_b32 v117, s51, v27
    v_fmac_f32 v14, v116, v64
    v_fmac_f32 v15, v117, v64
    v_lshlrev_b32 v116, 16, v36
    v_and_b32 v117, s51, v36
    v_fmac_f32 v0, v116, v68
    v_fmac_f32 v1, v117, v68
    v_lshlrev_b32 v116, 16, v37
    v_and_b32 v117, s51, v37
    v_fmac_f32 v2, v116, v68
    v_fmac_f32 v3, v117, v68
    v_lshlrev_b32 v116, 16, v38
    v_and_b32 v117, s51, v38
    v_fmac_f32 v12, v116, v68
    v_fmac_f32 v13, v117, v68
    v_lshlrev_b32 v116, 16, v39
    v_and_b32 v117, s51, v39
    v_fmac_f32 v14, v116, v68
    v_fmac_f32 v15, v117, v68
    v_lshlrev_b32 v116, 16, v48
    v_and_b32 v117, s51, v48
    v_fmac_f32 v0, v116, v72
    v_fmac_f32 v1, v117, v72
    v_lshlrev_b32 v116, 16, v49
    v_and_b32 v117, s51, v49
    v_fmac_f32 v2, v116, v72
    v_fmac_f32 v3, v117, v72
    v_lshlrev_b32 v116, 16, v50
    v_and_b32 v117, s51, v50
    v_fmac_f32 v12, v116, v72
    v_fmac_f32 v13, v117, v72
    v_lshlrev_b32 v116, 16, v51
    v_and_b32 v117, s51, v51
    v_fmac_f32 v14, v116, v72
    v_fmac_f32 v15, v117, v72
    v_mul_f32 v0, v0, v96
    v_mul_f32 v1, v1, v96
    v_mul_f32 v2, v2, v96
    v_mul_f32 v3, v3, v96
    v_mul_f32 v12, v12, v96
    v_mul_f32 v13, v13, v96
    v_mul_f32 v14, v14, v96
    v_mul_f32 v15, v15, v96
    v_cvt_pk_bf16_f32 v0, v0, v1
    v_cvt_pk_bf16_f32 v1, v2, v3
    v_cvt_pk_bf16_f32 v2, v12, v13
    v_cvt_pk_bf16_f32 v3, v14, v15
    s_nop 0
    v_permlane16_swap_b32 v0, v2
    v_permlane16_swap_b32 v1, v3
    s_nop 0
    buffer_store_dwordx4 v[0:3], v132, s[24:27], 0 offen sc1
    v_mul_f32 v4, v4, v61
    v_mul_f32 v5, v5, v61
    v_mul_f32 v6, v6, v61
    v_mul_f32 v7, v7, v61
    v_mul_f32 v16, v16, v61
    v_mul_f32 v17, v17, v61
    v_mul_f32 v18, v18, v61
    v_mul_f32 v19, v19, v61
    v_lshlrev_b32 v116, 16, v28
    v_and_b32 v117, s51, v28
    v_fmac_f32 v4, v116, v65
    v_fmac_f32 v5, v117, v65
    v_lshlrev_b32 v116, 16, v29
    v_and_b32 v117, s51, v29
    v_fmac_f32 v6, v116, v65
    v_fmac_f32 v7, v117, v65
    v_lshlrev_b32 v116, 16, v30
    v_and_b32 v117, s51, v30
    v_fmac_f32 v16, v116, v65
    v_fmac_f32 v17, v117, v65
    v_lshlrev_b32 v116, 16, v31
    v_and_b32 v117, s51, v31
    v_fmac_f32 v18, v116, v65
    v_fmac_f32 v19, v117, v65
    v_lshlrev_b32 v116, 16, v40
    v_and_b32 v117, s51, v40
    v_fmac_f32 v4, v116, v69
    v_fmac_f32 v5, v117, v69
    v_lshlrev_b32 v116, 16, v41
    v_and_b32 v117, s51, v41
    v_fmac_f32 v6, v116, v69
    v_fmac_f32 v7, v117, v69
    v_lshlrev_b32 v116, 16, v42
    v_and_b32 v117, s51, v42
    v_fmac_f32 v16, v116, v69
    v_fmac_f32 v17, v117, v69
    v_lshlrev_b32 v116, 16, v43
    v_and_b32 v117, s51, v43
    v_fmac_f32 v18, v116, v69
    v_fmac_f32 v19, v117, v69
    v_lshlrev_b32 v116, 16, v52
    v_and_b32 v117, s51, v52
    v_fmac_f32 v4, v116, v73
    v_fmac_f32 v5, v117, v73
    v_lshlrev_b32 v116, 16, v53
    v_and_b32 v117, s51, v53
    v_fmac_f32 v6, v116, v73
    v_fmac_f32 v7, v117, v73
    v_lshlrev_b32 v116, 16, v54
    v_and_b32 v117, s51, v54
    v_fmac_f32 v16, v116, v73
    v_fmac_f32 v17, v117, v73
    v_lshlrev_b32 v116, 16, v55
    v_and_b32 v117, s51, v55
    v_fmac_f32 v18, v116, v73
    v_fmac_f32 v19, v117, v73
    v_mul_f32 v4, v4, v97
    v_mul_f32 v5, v5, v97
    v_mul_f32 v6, v6, v97
    v_mul_f32 v7, v7, v97
    v_mul_f32 v16, v16, v97
    v_mul_f32 v17, v17, v97
    v_mul_f32 v18, v18, v97
    v_mul_f32 v19, v19, v97
    v_cvt_pk_bf16_f32 v4, v4, v5
    v_cvt_pk_bf16_f32 v5, v6, v7
    v_cvt_pk_bf16_f32 v6, v16, v17
    v_cvt_pk_bf16_f32 v7, v18, v19
    s_nop 0
    v_permlane16_swap_b32 v4, v6
    v_permlane16_swap_b32 v5, v7
    s_nop 0
    buffer_store_dwordx4 v[4:7], v132, s[24:27], s38 offen sc1
    v_mul_f32 v8, v8, v62
    v_mul_f32 v9, v9, v62
    v_mul_f32 v10, v10, v62
    v_mul_f32 v11, v11, v62
    v_mul_f32 v20, v20, v62
    v_mul_f32 v21, v21, v62
    v_mul_f32 v22, v22, v62
    v_mul_f32 v23, v23, v62
    v_lshlrev_b32 v116, 16, v32
    v_and_b32 v117, s51, v32
    v_fmac_f32 v8, v116, v66
    v_fmac_f32 v9, v117, v66
    v_lshlrev_b32 v116, 16, v33
    v_and_b32 v117, s51, v33
    v_fmac_f32 v10, v116, v66
    v_fmac_f32 v11, v117, v66
    v_lshlrev_b32 v116, 16, v34
    v_and_b32 v117, s51, v34
    v_fmac_f32 v20, v116, v66
    v_fmac_f32 v21, v117, v66
    v_lshlrev_b32 v116, 16, v35
    v_and_b32 v117, s51, v35
    v_fmac_f32 v22, v116, v66
    v_fmac_f32 v23, v117, v66
    v_lshlrev_b32 v116, 16, v44
    v_and_b32 v117, s51, v44
    v_fmac_f32 v8, v116, v70
    v_fmac_f32 v9, v117, v70
    v_lshlrev_b32 v116, 16, v45
    v_and_b32 v117, s51, v45
    v_fmac_f32 v10, v116, v70
    v_fmac_f32 v11, v117, v70
    v_lshlrev_b32 v116, 16, v46
    v_and_b32 v117, s51, v46
    v_fmac_f32 v20, v116, v70
    v_fmac_f32 v21, v117, v70
    v_lshlrev_b32 v116, 16, v47
    v_and_b32 v117, s51, v47
    v_fmac_f32 v22, v116, v70
    v_fmac_f32 v23, v117, v70
    v_lshlrev_b32 v116, 16, v56
    v_and_b32 v117, s51, v56
    v_fmac_f32 v8, v116, v74
    v_fmac_f32 v9, v117, v74
    v_lshlrev_b32 v116, 16, v57
    v_and_b32 v117, s51, v57
    v_fmac_f32 v10, v116, v74
    v_fmac_f32 v11, v117, v74
    v_lshlrev_b32 v116, 16, v58
    v_and_b32 v117, s51, v58
    v_fmac_f32 v20, v116, v74
    v_fmac_f32 v21, v117, v74
    v_lshlrev_b32 v116, 16, v59
    v_and_b32 v117, s51, v59
    v_fmac_f32 v22, v116, v74
    v_fmac_f32 v23, v117, v74
    v_mul_f32 v8, v8, v98
    v_mul_f32 v9, v9, v98
    v_mul_f32 v10, v10, v98
    v_mul_f32 v11, v11, v98
    v_mul_f32 v20, v20, v98
    v_mul_f32 v21, v21, v98
    v_mul_f32 v22, v22, v98
    v_mul_f32 v23, v23, v98
    v_cvt_pk_bf16_f32 v8, v8, v9
    v_cvt_pk_bf16_f32 v9, v10, v11
    v_cvt_pk_bf16_f32 v10, v20, v21
    v_cvt_pk_bf16_f32 v11, v22, v23
    s_nop 0
    v_permlane16_swap_b32 v8, v10
    v_permlane16_swap_b32 v9, v11
    s_nop 0
    buffer_store_dwordx4 v[8:11], v132, s[24:27], s39 offen sc1
    s_branch L_done
L_code_end:
L_slow:
    s_lshl_b32 s38, s16, 19
    s_lshl_b32 s39, s17, 17
    s_add_u32 s38, s38, s39
    s_add_u32 s20, s6, s38
    s_addc_u32 s21, s7, 0
    s_mov_b32 s22, 0x20000
    s_mov_b32 s23, 0x20000
    s_add_u32 s96, s8, s38
    s_addc_u32 s97, s9, 0
    s_mov_b32 s98, 0x20000
    s_mov_b32 s99, 0x20000
    s_movk_i32 s38, 0x1000
    s_movk_i32 s39, 0x2000
    v_mbcnt_lo_u32_b32 v142, -1, 0
    v_mbcnt_hi_u32_b32 v142, -1, v142
    v_and_b32 v96, 7, v142
    v_mul_u32_u24 v96, 1056, v96
    v_bfe_u32 v97, v142, 3, 1
    v_lshlrev_b32 v97, 8, v97
    v_and_b32 v98, 48, v142
    v_add3_u32 v138, v96, v97, v98
    v_bfe_u32 v96, v142, 2, 3
    v_mul_u32_u24 v96, 1056, v96
    v_lshrrev_b32 v97, 5, v142
    v_lshlrev_b32 v97, 8, v97
    v_and_b32 v99, 3, v142
    v_lshlrev_b32 v99, 3, v99
    v_add3_u32 v139, v96, v97, v99
    v_add_u32 v139, 8448, v139
    s_cmp_eq_u32 s19, 3
    s_cselect_b32 s42, 8, s19
    s_mul_i32 s42, s42, 16896
    v_add_u32 v138, s42, v138
    v_add_u32 v139, s42, v139
    v_lshlrev_b32 v142, 4, v142
    s_lshl_b32 s43, s17, 6
    v_xor_b32 v143, s43, v142
    v_mov_b32 v0, 0
    v_mov_b32 v1, 0
    v_mov_b32 v2, 0
    v_mov_b32 v3, 0
    v_mov_b32 v4, 0
    v_mov_b32 v5, 0
    v_mov_b32 v6, 0
    v_mov_b32 v7, 0
    v_mov_b32 v8, 0
    v_mov_b32 v9, 0
    v_mov_b32 v10, 0
    v_mov_b32 v11, 0
    v_mov_b32 v12, 0
    v_mov_b32 v13, 0
    v_mov_b32 v14, 0
    v_mov_b32 v15, 0
    v_mov_b32 v16, 0
    v_mov_b32 v17, 0
    v_mov_b32 v18, 0
    v_mov_b32 v19, 0
    v_mov_b32 v20, 0
    v_mov_b32 v21, 0
    v_mov_b32 v22, 0
    v_mov_b32 v23, 0
    v_mov_b32 v24, 0
    v_mov_b32 v25, 0
    v_mov_b32 v26, 0
    v_mov_b32 v27, 0
    v_mov_b32 v28, 0
    v_mov_b32 v29, 0
    v_mov_b32 v30, 0
    v_mov_b32 v31, 0
    v_mov_b32 v32, 0
    v_mov_b32 v33, 0
    v_mov_b32 v34, 0
    v_mov_b32 v35, 0
    v_mov_b32 v36, 0
    v_mov_b32 v37, 0
    v_mov_b32 v38, 0
    v_mov_b32 v39, 0
    v_mov_b32 v40, 0
    v_mov_b32 v41, 0
    v_mov_b32 v42, 0
    v_mov_b32 v43, 0
    v_mov_b32 v44, 0
    v_mov_b32 v45, 0
    v_mov_b32 v46, 0
    v_mov_b32 v47, 0
    v_mov_b32 v48, 0
    v_mov_b32 v49, 0
    v_mov_b32 v50, 0
    v_mov_b32 v51, 0
    v_mov_b32 v52, 0
    v_mov_b32 v53, 0
    v_mov_b32 v54, 0
    v_mov_b32 v55, 0
    v_mov_b32 v56, 0
    v_mov_b32 v57, 0
    v_mov_b32 v58, 0
    v_mov_b32 v59, 0
    v_mov_b32 v60, 0
    v_mov_b32 v61, 0
    v_mov_b32 v62, 0
    v_mov_b32 v63, 0
    v_mov_b32 v64, 0
    v_mov_b32 v65, 0
    v_mov_b32 v66, 0
    v_mov_b32 v67, 0
    v_mov_b32 v68, 0
    v_mov_b32 v69, 0
    v_mov_b32 v70, 0
    v_mov_b32 v71, 0
    v_mov_b32 v72, 0
    v_mov_b32 v73, 0
    v_mov_b32 v74, 0
    v_mov_b32 v75, 0
    v_mov_b32 v76, 0
    v_mov_b32 v77, 0
    v_mov_b32 v78, 0
    v_mov_b32 v79, 0
    v_mov_b32 v80, 0
    v_mov_b32 v81, 0
    v_mov_b32 v82, 0
    v_mov_b32 v83, 0
    v_mov_b32 v84, 0
    v_mov_b32 v85, 0
    v_mov_b32 v86, 0
    v_mov_b32 v87, 0
    v_mov_b32 v88, 0
    v_mov_b32 v89, 0
    v_mov_b32 v90, 0
    v_mov_b32 v91, 0
    v_mov_b32 v92, 0
    v_mov_b32 v93, 0
    v_mov_b32 v94, 0
    v_mov_b32 v95, 0
    v_mov_b32 v132, 0
    v_mov_b32 v133, 0
    v_mov_b32 v134, 0
    v_mov_b32 v135, 0
    v_mov_b32 v136, 0
    v_mov_b32 v137, 0
    v_mov_b32 v120, 0x7f000000
    v_mov_b32 v124, 0x7f000000
    v_mov_b32 v128, 0x7f000000
    s_mov_b32 s44, 0
L_slow_loop:
    s_mov_b32 s45, s44
    s_mov_b32 s46, s42
L_slow_ld:
    s_mov_b32 m0, s46
    s_add_u32 s47, s46, 8448
    buffer_load_dwordx4 v142, s[20:23], s45 offen lds
    s_mov_b32 m0, s47
    s_add_u32 s46, s46, 1056
    buffer_load_dwordx4 v143, s[96:99], s45 offen lds
    s_add_u32 s45, s45, 1024
    s_and_b32 s47, s45, 0x1fff
    s_cbranch_scc1 L_slow_ld
    s_waitcnt vmcnt(0)
    ds_read_b128 a[48:51], v138 offset:0
    ds_read_b128 a[52:55], v138 offset:64
    ds_read_b128 a[56:59], v138 offset:128
    ds_read_b128 a[60:63], v138 offset:192
    ds_read_b128 a[64:67], v138 offset:512
    ds_read_b128 a[68:71], v138 offset:576
    ds_read_b128 a[72:75], v138 offset:640
    ds_read_b128 a[76:79], v138 offset:704
    ds_read_b64_tr_b16 a[80:81], v139 offset:0
    ds_read_b64_tr_b16 a[82:83], v139 offset:512
    ds_read_b64_tr_b16 a[84:85], v139 offset:32
    ds_read_b64_tr_b16 a[86:87], v139 offset:544
    ds_read_b64_tr_b16 a[88:89], v139 offset:64
    ds_read_b64_tr_b16 a[90:91], v139 offset:576
    ds_read_b64_tr_b16 a[92:93], v139 offset:96
    ds_read_b64_tr_b16 a[94:95], v139 offset:608
    ds_read_b64_tr_b16 a[96:97], v139 offset:128
    ds_read_b64_tr_b16 a[98:99], v139 offset:640
    ds_read_b64_tr_b16 a[100:101], v139 offset:160
    ds_read_b64_tr_b16 a[102:103], v139 offset:672
    ds_read_b64_tr_b16 a[104:105], v139 offset:192
    ds_read_b64_tr_b16 a[106:107], v139 offset:704
    ds_read_b64_tr_b16 a[108:109], v139 offset:224
    ds_read_b64_tr_b16 a[110:111], v139 offset:736
    s_waitcnt lgkmcnt(0)
    v_mfma_f32_16x16x32_bf16 v[96:99], a[48:51], a[0:3], 0
    v_mfma_f32_16x16x32_bf16 v[96:99], a[52:55], a[4:7], v[96:99]
    v_mfma_f32_16x16x32_bf16 v[96:99], a[56:59], a[8:11], v[96:99]
    v_mfma_f32_16x16x32_bf16 v[96:99], a[60:63], a[12:15], v[96:99]
    v_mfma_f32_16x16x32_bf16 v[100:103], a[64:67], a[0:3], 0
    v_mfma_f32_16x16x32_bf16 v[100:103], a[68:71], a[4:7], v[100:103]
    v_mfma_f32_16x16x32_bf16 v[100:103], a[72:75], a[8:11], v[100:103]
    v_mfma_f32_16x16x32_bf16 v[100:103], a[76:79], a[12:15], v[100:103]
    s_nop 7
    v_max3_f32 v140, v96, v97, v98
    v_max3_f32 v140, v140, v99, v100
    v_max3_f32 v140, v140, v101, v102
    v_max3_f32 v140, v140, v103, -v120
    v_mov_b32 v141, v140
    s_nop 1
    v_permlane32_swap_b32 v140, v141
    s_nop 1
    v_max_f32 v140, v140, v141
    v_mov_b32 v141, v140
    s_nop 1
    v_permlane16_swap_b32 v140, v141
    s_nop 1
    v_max_f32 v140, v140, v141
    v_add_f32 v141, v120, v140
    v_exp_f32 v141, -v141
    v_sub_f32 v120, 0, v140
    v_sub_f32 v96, v96, v140
    v_sub_f32 v97, v97, v140
    v_sub_f32 v98, v98, v140
    v_sub_f32 v99, v99, v140
    v_sub_f32 v100, v100, v140
    v_sub_f32 v101, v101, v140
    v_sub_f32 v102, v102, v140
    v_sub_f32 v103, v103, v140
    v_exp_f32 v96, v96
    v_exp_f32 v97, v97
    v_exp_f32 v98, v98
    v_exp_f32 v99, v99
    v_exp_f32 v100, v100
    v_exp_f32 v101, v101
    v_exp_f32 v102, v102
    v_exp_f32 v103, v103
    v_mul_f32 v132, v132, v141
    v_mul_f32 v0, v0, v141
    v_mul_f32 v1, v1, v141
    v_mul_f32 v2, v2, v141
    v_mul_f32 v3, v3, v141
    v_mul_f32 v12, v12, v141
    v_mul_f32 v13, v13, v141
    v_mul_f32 v14, v14, v141
    v_mul_f32 v15, v15, v141
    v_mul_f32 v24, v24, v141
    v_mul_f32 v25, v25, v141
    v_mul_f32 v26, v26, v141
    v_mul_f32 v27, v27, v141
    v_mul_f32 v36, v36, v141
    v_mul_f32 v37, v37, v141
    v_mul_f32 v38, v38, v141
    v_mul_f32 v39, v39, v141
    v_mul_f32 v48, v48, v141
    v_mul_f32 v49, v49, v141
    v_mul_f32 v50, v50, v141
    v_mul_f32 v51, v51, v141
    v_mul_f32 v60, v60, v141
    v_mul_f32 v61, v61, v141
    v_mul_f32 v62, v62, v141
    v_mul_f32 v63, v63, v141
    v_mul_f32 v72, v72, v141
    v_mul_f32 v73, v73, v141
    v_mul_f32 v74, v74, v141
    v_mul_f32 v75, v75, v141
    v_mul_f32 v84, v84, v141
    v_mul_f32 v85, v85, v141
    v_mul_f32 v86, v86, v141
    v_mul_f32 v87, v87, v141
    v_cvt_pk_bf16_f32 v112, v96, v97
    v_cvt_pk_bf16_f32 v113, v98, v99
    v_cvt_pk_bf16_f32 v114, v100, v101
    v_cvt_pk_bf16_f32 v115, v102, v103
    v_add_f32 v132, v132, v96
    v_add_f32 v132, v132, v97
    v_add_f32 v132, v132, v98
    v_add_f32 v132, v132, v99
    v_add_f32 v132, v132, v100
    v_add_f32 v132, v132, v101
    v_add_f32 v132, v132, v102
    v_add_f32 v132, v132, v103
    v_mfma_f32_16x16x32_bf16 v[0:3], a[80:83], v[112:115], v[0:3]
    v_mfma_f32_16x16x32_bf16 v[12:15], a[84:87], v[112:115], v[12:15]
    v_mfma_f32_16x16x32_bf16 v[24:27], a[88:91], v[112:115], v[24:27]
    v_mfma_f32_16x16x32_bf16 v[36:39], a[92:95], v[112:115], v[36:39]
    v_mfma_f32_16x16x32_bf16 v[48:51], a[96:99], v[112:115], v[48:51]
    v_mfma_f32_16x16x32_bf16 v[60:63], a[100:103], v[112:115], v[60:63]
    v_mfma_f32_16x16x32_bf16 v[72:75], a[104:107], v[112:115], v[72:75]
    v_mfma_f32_16x16x32_bf16 v[84:87], a[108:111], v[112:115], v[84:87]
    v_mfma_f32_16x16x32_bf16 v[96:99], a[48:51], a[16:19], 0
    v_mfma_f32_16x16x32_bf16 v[96:99], a[52:55], a[20:23], v[96:99]
    v_mfma_f32_16x16x32_bf16 v[96:99], a[56:59], a[24:27], v[96:99]
    v_mfma_f32_16x16x32_bf16 v[96:99], a[60:63], a[28:31], v[96:99]
    v_mfma_f32_16x16x32_bf16 v[100:103], a[64:67], a[16:19], 0
    v_mfma_f32_16x16x32_bf16 v[100:103], a[68:71], a[20:23], v[100:103]
    v_mfma_f32_16x16x32_bf16 v[100:103], a[72:75], a[24:27], v[100:103]
    v_mfma_f32_16x16x32_bf16 v[100:103], a[76:79], a[28:31], v[100:103]
    s_nop 7
    v_max3_f32 v140, v96, v97, v98
    v_max3_f32 v140, v140, v99, v100
    v_max3_f32 v140, v140, v101, v102
    v_max3_f32 v140, v140, v103, -v124
    v_mov_b32 v141, v140
    s_nop 1
    v_permlane32_swap_b32 v140, v141
    s_nop 1
    v_max_f32 v140, v140, v141
    v_mov_b32 v141, v140
    s_nop 1
    v_permlane16_swap_b32 v140, v141
    s_nop 1
    v_max_f32 v140, v140, v141
    v_add_f32 v141, v124, v140
    v_exp_f32 v141, -v141
    v_sub_f32 v124, 0, v140
    v_sub_f32 v96, v96, v140
    v_sub_f32 v97, v97, v140
    v_sub_f32 v98, v98, v140
    v_sub_f32 v99, v99, v140
    v_sub_f32 v100, v100, v140
    v_sub_f32 v101, v101, v140
    v_sub_f32 v102, v102, v140
    v_sub_f32 v103, v103, v140
    v_exp_f32 v96, v96
    v_exp_f32 v97, v97
    v_exp_f32 v98, v98
    v_exp_f32 v99, v99
    v_exp_f32 v100, v100
    v_exp_f32 v101, v101
    v_exp_f32 v102, v102
    v_exp_f32 v103, v103
    v_mul_f32 v134, v134, v141
    v_mul_f32 v4, v4, v141
    v_mul_f32 v5, v5, v141
    v_mul_f32 v6, v6, v141
    v_mul_f32 v7, v7, v141
    v_mul_f32 v16, v16, v141
    v_mul_f32 v17, v17, v141
    v_mul_f32 v18, v18, v141
    v_mul_f32 v19, v19, v141
    v_mul_f32 v28, v28, v141
    v_mul_f32 v29, v29, v141
    v_mul_f32 v30, v30, v141
    v_mul_f32 v31, v31, v141
    v_mul_f32 v40, v40, v141
    v_mul_f32 v41, v41, v141
    v_mul_f32 v42, v42, v141
    v_mul_f32 v43, v43, v141
    v_mul_f32 v52, v52, v141
    v_mul_f32 v53, v53, v141
    v_mul_f32 v54, v54, v141
    v_mul_f32 v55, v55, v141
    v_mul_f32 v64, v64, v141
    v_mul_f32 v65, v65, v141
    v_mul_f32 v66, v66, v141
    v_mul_f32 v67, v67, v141
    v_mul_f32 v76, v76, v141
    v_mul_f32 v77, v77, v141
    v_mul_f32 v78, v78, v141
    v_mul_f32 v79, v79, v141
    v_mul_f32 v88, v88, v141
    v_mul_f32 v89, v89, v141
    v_mul_f32 v90, v90, v141
    v_mul_f32 v91, v91, v141
    v_cvt_pk_bf16_f32 v112, v96, v97
    v_cvt_pk_bf16_f32 v113, v98, v99
    v_cvt_pk_bf16_f32 v114, v100, v101
    v_cvt_pk_bf16_f32 v115, v102, v103
    v_add_f32 v134, v134, v96
    v_add_f32 v134, v134, v97
    v_add_f32 v134, v134, v98
    v_add_f32 v134, v134, v99
    v_add_f32 v134, v134, v100
    v_add_f32 v134, v134, v101
    v_add_f32 v134, v134, v102
    v_add_f32 v134, v134, v103
    v_mfma_f32_16x16x32_bf16 v[4:7], a[80:83], v[112:115], v[4:7]
    v_mfma_f32_16x16x32_bf16 v[16:19], a[84:87], v[112:115], v[16:19]
    v_mfma_f32_16x16x32_bf16 v[28:31], a[88:91], v[112:115], v[28:31]
    v_mfma_f32_16x16x32_bf16 v[40:43], a[92:95], v[112:115], v[40:43]
    v_mfma_f32_16x16x32_bf16 v[52:55], a[96:99], v[112:115], v[52:55]
    v_mfma_f32_16x16x32_bf16 v[64:67], a[100:103], v[112:115], v[64:67]
    v_mfma_f32_16x16x32_bf16 v[76:79], a[104:107], v[112:115], v[76:79]
    v_mfma_f32_16x16x32_bf16 v[88:91], a[108:111], v[112:115], v[88:91]
    v_mfma_f32_16x16x32_bf16 v[96:99], a[48:51], a[32:35], 0
    v_mfma_f32_16x16x32_bf16 v[96:99], a[52:55], a[36:39], v[96:99]
    v_mfma_f32_16x16x32_bf16 v[96:99], a[56:59], a[40:43], v[96:99]
    v_mfma_f32_16x16x32_bf16 v[96:99], a[60:63], a[44:47], v[96:99]
    v_mfma_f32_16x16x32_bf16 v[100:103], a[64:67], a[32:35], 0
    v_mfma_f32_16x16x32_bf16 v[100:103], a[68:71], a[36:39], v[100:103]
    v_mfma_f32_16x16x32_bf16 v[100:103], a[72:75], a[40:43], v[100:103]
    v_mfma_f32_16x16x32_bf16 v[100:103], a[76:79], a[44:47], v[100:103]
    s_nop 7
    v_max3_f32 v140, v96, v97, v98
    v_max3_f32 v140, v140, v99, v100
    v_max3_f32 v140, v140, v101, v102
    v_max3_f32 v140, v140, v103, -v128
    v_mov_b32 v141, v140
    s_nop 1
    v_permlane32_swap_b32 v140, v141
    s_nop 1
    v_max_f32 v140, v140, v141
    v_mov_b32 v141, v140
    s_nop 1
    v_permlane16_swap_b32 v140, v141
    s_nop 1
    v_max_f32 v140, v140, v141
    v_add_f32 v141, v128, v140
    v_exp_f32 v141, -v141
    v_sub_f32 v128, 0, v140
    v_sub_f32 v96, v96, v140
    v_sub_f32 v97, v97, v140
    v_sub_f32 v98, v98, v140
    v_sub_f32 v99, v99, v140
    v_sub_f32 v100, v100, v140
    v_sub_f32 v101, v101, v140
    v_sub_f32 v102, v102, v140
    v_sub_f32 v103, v103, v140
    v_exp_f32 v96, v96
    v_exp_f32 v97, v97
    v_exp_f32 v98, v98
    v_exp_f32 v99, v99
    v_exp_f32 v100, v100
    v_exp_f32 v101, v101
    v_exp_f32 v102, v102
    v_exp_f32 v103, v103
    v_mul_f32 v136, v136, v141
    v_mul_f32 v8, v8, v141
    v_mul_f32 v9, v9, v141
    v_mul_f32 v10, v10, v141
    v_mul_f32 v11, v11, v141
    v_mul_f32 v20, v20, v141
    v_mul_f32 v21, v21, v141
    v_mul_f32 v22, v22, v141
    v_mul_f32 v23, v23, v141
    v_mul_f32 v32, v32, v141
    v_mul_f32 v33, v33, v141
    v_mul_f32 v34, v34, v141
    v_mul_f32 v35, v35, v141
    v_mul_f32 v44, v44, v141
    v_mul_f32 v45, v45, v141
    v_mul_f32 v46, v46, v141
    v_mul_f32 v47, v47, v141
    v_mul_f32 v56, v56, v141
    v_mul_f32 v57, v57, v141
    v_mul_f32 v58, v58, v141
    v_mul_f32 v59, v59, v141
    v_mul_f32 v68, v68, v141
    v_mul_f32 v69, v69, v141
    v_mul_f32 v70, v70, v141
    v_mul_f32 v71, v71, v141
    v_mul_f32 v80, v80, v141
    v_mul_f32 v81, v81, v141
    v_mul_f32 v82, v82, v141
    v_mul_f32 v83, v83, v141
    v_mul_f32 v92, v92, v141
    v_mul_f32 v93, v93, v141
    v_mul_f32 v94, v94, v141
    v_mul_f32 v95, v95, v141
    v_cvt_pk_bf16_f32 v112, v96, v97
    v_cvt_pk_bf16_f32 v113, v98, v99
    v_cvt_pk_bf16_f32 v114, v100, v101
    v_cvt_pk_bf16_f32 v115, v102, v103
    v_add_f32 v136, v136, v96
    v_add_f32 v136, v136, v97
    v_add_f32 v136, v136, v98
    v_add_f32 v136, v136, v99
    v_add_f32 v136, v136, v100
    v_add_f32 v136, v136, v101
    v_add_f32 v136, v136, v102
    v_add_f32 v136, v136, v103
    v_mfma_f32_16x16x32_bf16 v[8:11], a[80:83], v[112:115], v[8:11]
    v_mfma_f32_16x16x32_bf16 v[20:23], a[84:87], v[112:115], v[20:23]
    v_mfma_f32_16x16x32_bf16 v[32:35], a[88:91], v[112:115], v[32:35]
    v_mfma_f32_16x16x32_bf16 v[44:47], a[92:95], v[112:115], v[44:47]
    v_mfma_f32_16x16x32_bf16 v[56:59], a[96:99], v[112:115], v[56:59]
    v_mfma_f32_16x16x32_bf16 v[68:71], a[100:103], v[112:115], v[68:71]
    v_mfma_f32_16x16x32_bf16 v[80:83], a[104:107], v[112:115], v[80:83]
    v_mfma_f32_16x16x32_bf16 v[92:95], a[108:111], v[112:115], v[92:95]
    s_add_u32 s44, s44, 0x2000
    s_cmp_lt_u32 s44, 0x20000
    s_cbranch_scc1 L_slow_loop
    s_nop 7
    v_mov_b32 v140, v132
    v_mov_b32 v141, v134
    v_mov_b32 v142, v136
    s_nop 0
    v_permlane32_swap_b32 v132, v140
    v_permlane32_swap_b32 v134, v141
    v_permlane32_swap_b32 v136, v142
    s_nop 0
    v_add_f32 v132, v132, v140
    v_add_f32 v134, v134, v141
    v_add_f32 v136, v136, v142
    v_mov_b32 v140, v132
    v_mov_b32 v141, v134
    v_mov_b32 v142, v136
    s_nop 0
    v_permlane16_swap_b32 v132, v140
    v_permlane16_swap_b32 v134, v141
    v_permlane16_swap_b32 v136, v142
    s_nop 0
    v_add_f32 v132, v132, v140
    v_add_f32 v134, v134, v141
    v_add_f32 v136, v136, v142
    v_mbcnt_lo_u32_b32 v143, -1, 0
    v_mbcnt_hi_u32_b32 v143, -1, v143
    v_lshlrev_b32 v143, 4, v143
    v_and_b32 v142, 0xf0, v143
    v_mov_b32 v140, 0
    v_mov_b32 v100, v120
    v_mov_b32 v101, v124
    v_mov_b32 v102, v128
    v_mov_b32 v103, 0
    buffer_store_dwordx4 v[100:103], v142, s[28:31], s59 offen offset:256 sc1
    v_mov_b32 v96, v132
    v_mov_b32 v97, v134
    v_mov_b32 v98, v136
    v_mov_b32 v99, 1
    buffer_store_dwordx4 v[96:99], v142, s[28:31], s59 offen sc1
    v_cvt_pk_bf16_f32 v24, v24, v25
    v_cvt_pk_bf16_f32 v25, v26, v27
    v_cvt_pk_bf16_f32 v26, v36, v37
    v_cvt_pk_bf16_f32 v27, v38, v39
    buffer_store_dwordx4 v[24:27], v143, s[28:31], s56 offen offset:0 sc1
    v_cvt_pk_bf16_f32 v48, v48, v49
    v_cvt_pk_bf16_f32 v49, v50, v51
    v_cvt_pk_bf16_f32 v50, v60, v61
    v_cvt_pk_bf16_f32 v51, v62, v63
    buffer_store_dwordx4 v[48:51], v143, s[28:31], s57 offen offset:0 sc1
    v_cvt_pk_bf16_f32 v72, v72, v73
    v_cvt_pk_bf16_f32 v73, v74, v75
    v_cvt_pk_bf16_f32 v74, v84, v85
    v_cvt_pk_bf16_f32 v75, v86, v87
    buffer_store_dwordx4 v[72:75], v143, s[28:31], s58 offen offset:0 sc1
    v_cvt_pk_bf16_f32 v28, v28, v29
    v_cvt_pk_bf16_f32 v29, v30, v31
    v_cvt_pk_bf16_f32 v30, v40, v41
    v_cvt_pk_bf16_f32 v31, v42, v43
    buffer_store_dwordx4 v[28:31], v143, s[28:31], s56 offen offset:1024
    v_cvt_pk_bf16_f32 v52, v52, v53
    v_cvt_pk_bf16_f32 v53, v54, v55
    v_cvt_pk_bf16_f32 v54, v64, v65
    v_cvt_pk_bf16_f32 v55, v66, v67
    buffer_store_dwordx4 v[52:55], v143, s[28:31], s57 offen offset:1024
    v_cvt_pk_bf16_f32 v76, v76, v77
    v_cvt_pk_bf16_f32 v77, v78, v79
    v_cvt_pk_bf16_f32 v78, v88, v89
    v_cvt_pk_bf16_f32 v79, v90, v91
    buffer_store_dwordx4 v[76:79], v143, s[28:31], s58 offen offset:1024
    v_cvt_pk_bf16_f32 v32, v32, v33
    v_cvt_pk_bf16_f32 v33, v34, v35
    v_cvt_pk_bf16_f32 v34, v44, v45
    v_cvt_pk_bf16_f32 v35, v46, v47
    buffer_store_dwordx4 v[32:35], v143, s[28:31], s56 offen offset:2048
    v_cvt_pk_bf16_f32 v56, v56, v57
    v_cvt_pk_bf16_f32 v57, v58, v59
    v_cvt_pk_bf16_f32 v58, v68, v69
    v_cvt_pk_bf16_f32 v59, v70, v71
    buffer_store_dwordx4 v[56:59], v143, s[28:31], s57 offen offset:2048
    v_cvt_pk_bf16_f32 v80, v80, v81
    v_cvt_pk_bf16_f32 v81, v82, v83
    v_cvt_pk_bf16_f32 v82, v92, v93
    v_cvt_pk_bf16_f32 v83, v94, v95
    buffer_store_dwordx4 v[80:83], v143, s[28:31], s58 offen offset:2048
    s_branch L_sent
.section .rodata,"a"
.p2align 6
.amdhsa_kernel standalone__gqa_softmax__near_ridge_kernel
  .amdhsa_next_free_vgpr 256
  .amdhsa_next_free_sgpr 102
  .amdhsa_accum_offset 144
  .amdhsa_group_segment_fixed_size 0
  .amdhsa_kernarg_size 48
  .amdhsa_user_sgpr_count 2
  .amdhsa_user_sgpr_kernarg_segment_ptr 1
  .amdhsa_system_sgpr_workgroup_id_x 1
.end_amdhsa_kernel
```
